```python
import torch

def _softmax(x, axis=-1):
    return torch.softmax(x, dim=axis)
def _gelu(x):
    return torch.nn.functional.gelu(x, approximate="tanh")
def _silu(x):
    return torch.nn.functional.silu(x)
def _sigmoid(x):
    return torch.sigmoid(x)
def _layernorm(x, axis=-1, eps=1e-5):
    m = x.mean(dim=axis, keepdim=True)
    v = x.var(dim=axis, keepdim=True, unbiased=False)
    return (x - m) / torch.sqrt(v + eps)
def _scatter_add(tgt, idx, src, axis=0):
    return tgt.clone().index_add_(axis, idx, src)
def _segment_sum(src, seg, n):
    out = torch.zeros((n,) + src.shape[1:], dtype=src.dtype)
    return out.index_add_(0, seg, src)
def _pad(x, pw):
    flat = tuple(v for pair in reversed(pw) for v in pair)
    return torch.nn.functional.pad(x, flat)

kernel_name = 'parallel_sum__gqa_block_cached__glu_gated_geglu__decode'

def setup_inputs():

    _w = (lambda a: (lambda t: t.to(torch.bfloat16) if t.is_floating_point() else t)(torch.as_tensor(a)))
    def _A_setup():
        B, Sq, D = 8, 1, 1024
        Hq, Hkv, Sk, Dh = 32, 4, 8192, 128
        assert Hq % Hkv == 0, (Hq, Hkv)
        return {
            "x": _w((lambda *s: torch.randn(*s, dtype=torch.bfloat16) * 0.05)(B, Sq, D)),
            "k_cache": _w((lambda *s: torch.randn(*s, dtype=torch.bfloat16) * 1.6)(B, Hkv, Sk, Dh)),
            "v_cache": _w((lambda *s: torch.randn(*s, dtype=torch.bfloat16) * 0.8)(B, Hkv, Sk, Dh)),
            "wq": _w((lambda *s: torch.randn(*s, dtype=torch.bfloat16) * 1.6)(D, Hq * Dh) * (D ** -0.5)),
            "wo": _w((lambda *s: torch.randn(*s, dtype=torch.bfloat16) * 0.8)(Hq * Dh, D) * ((Hq * Dh) ** -0.5)),
        }
    _A_in = _A_setup()

    def _B_setup():
        B, S, Dm, Df = 8, 1, 1024, 3584
        return {
            "x": _w((lambda *s: torch.randn(*s, dtype=torch.bfloat16) * 0.05)(B, S, Dm)),
            "w_gate": _w((lambda *s: torch.randn(*s, dtype=torch.bfloat16) * 0.4)(Dm, Df) * (Dm ** -0.5)),
            "w_up": _w((lambda *s: torch.randn(*s, dtype=torch.bfloat16) * 0.4)(Dm, Df) * (Dm ** -0.5)),
            "w_down": _w((lambda *s: torch.randn(*s, dtype=torch.bfloat16) * 0.4)(Df, Dm) * (Df ** -0.5)),
        }
    _B_in = _B_setup()

    return {
        "A_x": _A_in["x"],
        "A_k_cache": _A_in["k_cache"],
        "A_v_cache": _A_in["v_cache"],
        "A_wq": _A_in["wq"],
        "A_wo": _A_in["wo"],
        "B_x": _B_in["x"],
        "B_w_gate": _B_in["w_gate"],
        "B_w_up": _B_in["w_up"],
        "B_w_down": _B_in["w_down"],
    }

def reference(A_x, A_k_cache, A_v_cache, A_wq, A_wo, B_x, B_w_gate, B_w_up, B_w_down):
    def _A_ref(x, k_cache, v_cache, wq, wo):
        B, Sq, D = x.shape
        Hq, Dh = 32, 128
        Hkv = k_cache.shape[1]
        rep = Hq // Hkv
        q = (lambda x, *d: x.permute(*d))((x @ wq).reshape(B, Sq, Hq, Dh), 0, 2, 1, 3)
        k = (lambda x, n, axis: torch.repeat_interleave(x, n, dim=axis))(k_cache, rep, axis=1)
        v = (lambda x, n, axis: torch.repeat_interleave(x, n, dim=axis))(v_cache, rep, axis=1)
        scores = torch.einsum("bhqd,bhkd->bhqk", q, k) * (Dh ** -0.5)
        p = _softmax(scores, axis=-1)
        o = torch.einsum("bhqk,bhkd->bhqd", p, v)
        return (lambda x, *d: x.permute(*d))(o, 0, 2, 1, 3).reshape(B, Sq, Hq * Dh) @ wo

    def _B_ref(x, w_gate, w_up, w_down):
        g = torch.einsum("bsd,df->bsf", x, w_gate)
        u = torch.einsum("bsd,df->bsf", x, w_up)
        h = _gelu(g) * u
        return torch.einsum("bsf,fd->bsd", h, w_down)

    x = A_x
    xn = _layernorm(x, axis=-1)
    return x + _A_ref(xn, A_k_cache, A_v_cache, A_wq, A_wo) + _B_ref(xn, B_w_gate, B_w_up, B_w_down)
```

```asm
; @launch grid=(256,1,1) block=(1024,1,1) lds=141312
.amdgcn_target "amdgcn-amd-amdhsa--gfx950"
.text
.globl parallel_sum__gqa_block_cached__glu_gated_geglu__decode_kernel
.p2align 8
.type parallel_sum__gqa_block_cached__glu_gated_geglu__decode_kernel,@function
parallel_sum__gqa_block_cached__glu_gated_geglu__decode_kernel:
    s_memrealtime s[94:95]
    s_cmp_ge_u32 s2, 256
    s_cbranch_scc1 L_end
    s_load_dwordx16 s[16:31], s[0:1], 0
    s_load_dwordx8 s[32:39], s[0:1], 64
    v_lshrrev_b32 v1, 6, v0
    s_nop 0
    v_readfirstlane_b32 s3, v1
    v_and_b32 v0, 63, v0
    s_and_b32 s4, s2, 31
    s_lshr_b32 s81, s2, 5
    s_lshl_b32 s78, s4, 3
    s_add_u32 s78, s78, s81
    s_lshr_b32 s79, s4, 2
    s_and_b32 s80, s4, 3
    s_lshr_b32 s82, s2, 6
    s_and_b32 s83, s2, 63
    s_mul_i32 s98, s2, 1171
    s_lshr_b32 s98, s98, 16
    s_mul_i32 s5, s98, 56
    s_sub_u32 s97, s2, s5
    s_cmp_ge_u32 s3, 12
    s_cselect_b32 s5, 6, 3
    s_add_u32 s97, s97, s5
    s_sub_u32 s5, s97, 56
    s_cmp_ge_u32 s97, 56
    s_cselect_b32 s97, s5, s97
    s_sub_u32 s8, s3, 4
    s_lshr_b32 s88, s8, 2
    s_and_b32 s10, s8, 3
    s_movk_i32 s85, 7168
    s_cmp_eq_u32 s88, 0
    s_cselect_b32 s85, 8192, s85
    s_cselect_b32 s11, s82, s98
    s_cselect_b32 s12, s83, s97
    s_lshl_b32 s96, s11, 8
    s_lshl_b32 s13, s10, 6
    s_add_u32 s96, s96, s13
    s_mul_i32 s84, s96, s85
    s_lshl_b32 s12, s12, 7
    s_add_u32 s84, s84, s12
    s_lshl_b32 s12, s4, 21
    v_lshrrev_b32 v3, 4, v0
    v_lshlrev_b32 v3, 3, v3
    v_bfe_u32 v4, v0, 3, 1
    v_lshl_add_u32 v3, v4, 5, v3
    v_mul_lo_u32 v3, v3, s85
    v_and_b32 v4, 7, v0
    v_lshl_add_u32 v3, v4, 4, v3
    v_lshrrev_b32 v5, 5, v0
    v_lshlrev_b32 v5, 11, v5
    v_and_b32 v4, 31, v0
    v_lshl_add_u32 v5, v4, 4, v5
    s_lshl_b32 s13, s3, 12
    s_lshr_b32 s6, s2, 2
    s_lshl_b32 s6, s6, 7
    s_and_b32 s7, s2, 3
    s_lshl_b32 s7, s7, 2
    s_add_u32 s6, s6, s7
    s_add_u32 s101, s6, 0x380000
    v_lshlrev_b32 v2, 4, v0
    v_mov_b32 v60, -1
    v_mov_b32 v61, -1
    v_mov_b32 v62, -1
    v_mov_b32 v63, -1
    v_lshlrev_b32 v6, 2, v0
    v_and_b32 v7, 15, v0
    v_lshrrev_b32 v56, 4, v0
    v_lshlrev_b32 v56, 14, v56
    v_lshl_add_u32 v56, v7, 4, v56
    s_lshl_b32 s4, s82, 9
    s_add_u32 s4, s4, s83
    s_lshl_b32 s4, s4, 8
    s_lshl_b32 s6, s78, 7
    s_add_u32 s6, s6, 0x300000
    v_add_u32 v57, s6, v6
    v_writelane_b32 v57, s101, 16
    s_add_u32 s6, s101, 64
    v_writelane_b32 v57, s6, 17
    s_cmp_lg_u32 s3, 0
    s_cbranch_scc1 L_noinit
    v_mov_b32 v7, 0
    s_mov_b32 exec_hi, 0
    ds_write_b32 v6, v7 offset:6272
    s_mov_b64 exec, -1
L_noinit:
    s_waitcnt lgkmcnt(0)
    s_lshr_b32 s14, s2, 3
    s_mul_i32 s14, s14, 0
    s_lshr_b32 s14, s14, 4
    s_sub_u32 s100, s94, s14
    s_mov_b32 s40, s16
    s_and_b32 s41, s17, 0xffff
    s_mov_b32 s42, 0x4000
    s_mov_b32 s43, 0x00020000
    s_and_b32 s14, s2, 7
    s_lshl3_add_u32 s14, s82, s14
    s_lshl_b32 s14, s14, 2
    s_add_u32 s93, s14, 0x390000
    s_bfe_u32 s15, s2, 0x30003
    s_cmp_eq_u32 s15, 3
    s_cselect_b32 s93, s93, -1
    s_mov_b32 s92, 0
    s_mov_b32 s60, s38
    s_and_b32 s61, s39, 0xffff
    s_mov_b32 s62, 0x1000000
    s_mov_b32 s63, 0x00020000
    s_cmp_lt_u32 s3, 4
    s_cbranch_scc1 L_xload
    s_cmp_eq_u32 s88, 1
    s_cselect_b32 s52, s28, s30
    s_cselect_b32 s53, s29, s31
    s_mov_b32 s54, 0x700000
    s_cmp_eq_u32 s88, 0
    s_cselect_b32 s52, s22, s52
    s_cselect_b32 s53, s23, s53
    s_cselect_b32 s54, 0x800000, s54
    s_and_b32 s53, s53, 0xffff
    s_mov_b32 s55, 0x00020000
    s_cmp_lt_u32 s3, 8
    s_cbranch_scc1 L_w1go
    s_barrier
    s_cmp_ge_u32 s2, 224
    s_cbranch_scc1 L_pro3
L_w1go:
    s_mov_b32 s4, s84
    buffer_load_dwordx4 v[12:15], v3, s[52:55], s4 offen nt
    s_add_u32 s4, s4, s85
    buffer_load_dwordx4 v[16:19], v3, s[52:55], s4 offen nt
    s_add_u32 s4, s4, s85
    buffer_load_dwordx4 v[20:23], v3, s[52:55], s4 offen nt
    s_add_u32 s4, s4, s85
    buffer_load_dwordx4 v[24:27], v3, s[52:55], s4 offen nt
    s_add_u32 s4, s4, s85
    buffer_load_dwordx4 v[28:31], v3, s[52:55], s4 offen nt
    s_add_u32 s4, s4, s85
    buffer_load_dwordx4 v[32:35], v3, s[52:55], s4 offen nt
    s_add_u32 s4, s4, s85
    buffer_load_dwordx4 v[36:39], v3, s[52:55], s4 offen nt
    s_add_u32 s4, s4, s85
    buffer_load_dwordx4 v[40:43], v3, s[52:55], s4 offen nt
    s_cmp_lt_u32 s3, 8
    s_cbranch_scc1 L_pro2
    v_mov_b32 v6, 6272
    v_mov_b32 v7, 0x10000
    s_mov_b64 exec, 1
    ds_add_u32 v6, v7 offset:8
    s_mov_b64 exec, -1
    s_branch L_pro3
L_xload:
    buffer_load_dwordx4 v[12:15], v5, s[40:43], s13 offen offset:0
    buffer_load_dwordx4 v[16:19], v5, s[40:43], s13 offen offset:512
    buffer_load_dwordx4 v[20:23], v5, s[40:43], s13 offen offset:1024
    buffer_load_dwordx4 v[24:27], v5, s[40:43], s13 offen offset:1536
    s_cmp_lg_u32 s3, 0
    s_cbranch_scc1 L_pro2
    buffer_store_dwordx4 v[60:63], v56, s[60:63], s4 offen sc1
    s_add_u32 s4, s4, 65536
    buffer_store_dwordx4 v[60:63], v56, s[60:63], s4 offen sc1
    s_mov_b64 exec, 0x3ffff
    buffer_store_dword v60, v57, s[60:63], 0 offen sc1
    s_mov_b64 exec, -1
L_pro2:
    s_setprio 3
    s_barrier
L_pro3:
    s_add_u32 s44, s18, s12
    s_addc_u32 s45, s19, 0
    s_and_b32 s45, s45, 0xffff
    s_mov_b32 s46, 0x200000
    s_mov_b32 s47, 0x00020000
    s_add_u32 s48, s20, s12
    s_addc_u32 s49, s21, 0
    s_and_b32 s49, s49, 0xffff
    s_mov_b32 s50, 0x200000
    s_mov_b32 s51, 0x00020000
    s_mov_b32 s64, s34
    s_and_b32 s65, s35, 0xffff
    s_mov_b32 s66, 0x4000
    s_mov_b32 s67, 0x00020000
    s_mov_b32 s68, s36
    s_and_b32 s69, s37, 0xffff
    s_mov_b32 s70, 0x100
    s_mov_b32 s71, 0x00020000
    s_mov_b32 s72, 0x05040100
    s_mov_b32 s73, 0x07060302
    s_mov_b32 s87, 0x3fb8aa3b
    s_mov_b32 s99, 0x3db504f3
    v_and_b32 v6, 3, v0
    v_lshlrev_b32 v6, 10, v6
    v_bfe_u32 v4, v0, 2, 1
    v_lshl_add_u32 v6, v4, 8, v6
    v_bfe_u32 v4, v0, 3, 1
    v_lshl_add_u32 v6, v4, 6, v6
    v_lshrrev_b32 v4, 4, v0
    v_lshl_add_u32 v1, v4, 4, v6
    s_lshr_b32 s6, s2, 0
    s_add_u32 s6, s6, s3
    s_and_b32 s6, s6, 15
    s_lshl_b32 s6, s6, 17
    s_lshl_b32 s7, s81, 14
    s_add_u32 s6, s6, s7
    s_add_u32 s7, s3, s2
    s_add_u32 s8, s7, 0
    s_and_b32 s8, s8, 3
    s_lshl_b32 s8, s8, 12
    s_add_u32 s74, s6, s8
    s_add_u32 s8, s7, 1
    s_and_b32 s8, s8, 3
    s_lshl_b32 s8, s8, 12
    s_add_u32 s75, s6, s8
    s_add_u32 s8, s7, 2
    s_and_b32 s8, s8, 3
    s_lshl_b32 s8, s8, 12
    s_add_u32 s76, s6, s8
    s_add_u32 s8, s7, 3
    s_and_b32 s8, s8, 3
    s_lshl_b32 s8, s8, 12
    s_add_u32 s77, s6, s8
    s_lshr_b32 s4, s3, 2
    s_lshl_b32 s4, s4, 4
    s_and_b32 s5, s3, 3
    s_cmp_lt_u32 s2, 224
    s_mov_b32 s6, 0x19004eb
    s_mov_b32 s7, 0x3f102f7
    s_cselect_b32 s6, 0x19004eb, s6
    s_cselect_b32 s7, 0x3f102f7, s7
    s_movk_i32 s8, 1000
    s_cselect_b32 s8, 1000, s8
    s_lshr_b64 s[6:7], s[6:7], s4
    s_and_b32 s6, s6, 0xffff
    s_mul_i32 s7, s5, s8
    s_mul_i32 s8, s7, 23
    s_lshr_b32 s8, s8, 4
    s_cmp_eq_u32 s4, 16
    s_cselect_b32 s7, s8, s7
    s_lshr_b32 s7, s7, 4
    s_add_u32 s6, s6, s7
    s_add_u32 s90, s6, s100
    s_cmp_lt_u32 s2, 224
    s_mov_b32 s6, 0x5e508c7
    s_mov_b32 s7, 0x7d106db
    s_cselect_b32 s6, 0x5e508c7, s6
    s_cselect_b32 s7, 0x7d106db, s7
    s_movk_i32 s8, 984
    s_lshr_b64 s[6:7], s[6:7], s4
    s_and_b32 s6, s6, 0xffff
    s_mul_i32 s7, s5, s8
    s_lshr_b32 s7, s7, 4
    s_add_u32 s6, s6, s7
    s_add_u32 s91, s6, s100
    s_mul_i32 s6, s2, 1
    s_and_b32 s6, s6, 31
    s_mul_i32 s6, s6, 31
    s_lshr_b32 s6, s6, 4
    s_add_u32 s91, s91, s6
    s_sub_u32 s91, s91, 31
    s_cmp_ge_u32 s3, 4
    s_cbranch_scc1 L_p1
    s_cmp_eq_u32 s3, 0
    s_cbranch_scc1 L_ln0
    s_waitcnt vmcnt(0)
    s_branch L_ln1
L_ln0:
    s_waitcnt vmcnt(3)
    s_cmp_lt_i32 s93, 0
    s_cbranch_scc1 L_ln1
    v_mov_b32 v4, 0
    v_mov_b32 v5, s100
    s_and_b32 s4, s93, 63
    s_and_b32 s5, s93, 64
    s_lshl1_add_u32 s4, s5, s4
    s_mov_b64 exec, 1
    buffer_store_dword v4, off, s[60:63], s93 sc1
    buffer_store_dword v5, off, s[68:71], s4 sc1
    s_mov_b64 exec, -1
L_ln1:
    v_lshlrev_b32 v28, 16, v12
    v_and_b32 v29, 0xffff0000, v12
    v_lshlrev_b32 v30, 16, v13
    v_and_b32 v31, 0xffff0000, v13
    v_lshlrev_b32 v32, 16, v14
    v_and_b32 v33, 0xffff0000, v14
    v_lshlrev_b32 v34, 16, v15
    v_and_b32 v35, 0xffff0000, v15
    v_lshlrev_b32 v36, 16, v16
    v_and_b32 v37, 0xffff0000, v16
    v_lshlrev_b32 v38, 16, v17
    v_and_b32 v39, 0xffff0000, v17
    v_lshlrev_b32 v40, 16, v18
    v_and_b32 v41, 0xffff0000, v18
    v_lshlrev_b32 v42, 16, v19
    v_and_b32 v43, 0xffff0000, v19
    v_lshlrev_b32 v44, 16, v20
    v_and_b32 v45, 0xffff0000, v20
    v_lshlrev_b32 v46, 16, v21
    v_and_b32 v47, 0xffff0000, v21
    v_lshlrev_b32 v48, 16, v22
    v_and_b32 v49, 0xffff0000, v22
    v_lshlrev_b32 v50, 16, v23
    v_and_b32 v51, 0xffff0000, v23
    v_lshlrev_b32 v52, 16, v24
    v_and_b32 v53, 0xffff0000, v24
    v_lshlrev_b32 v54, 16, v25
    v_and_b32 v55, 0xffff0000, v25
    v_lshlrev_b32 v56, 16, v26
    v_and_b32 v57, 0xffff0000, v26
    v_lshlrev_b32 v58, 16, v27
    v_and_b32 v59, 0xffff0000, v27
    v_add_f32 v4, v28, v29
    v_add_f32 v5, v30, v31
    v_add_f32 v4, v4, v32
    v_add_f32 v5, v5, v33
    v_add_f32 v4, v4, v34
    v_add_f32 v5, v5, v35
    v_add_f32 v4, v4, v36
    v_add_f32 v5, v5, v37
    v_add_f32 v4, v4, v38
    v_add_f32 v5, v5, v39
    v_add_f32 v4, v4, v40
    v_add_f32 v5, v5, v41
    v_add_f32 v4, v4, v42
    v_add_f32 v5, v5, v43
    v_add_f32 v4, v4, v44
    v_add_f32 v5, v5, v45
    v_add_f32 v4, v4, v46
    v_add_f32 v5, v5, v47
    v_add_f32 v4, v4, v48
    v_add_f32 v5, v5, v49
    v_add_f32 v4, v4, v50
    v_add_f32 v5, v5, v51
    v_add_f32 v4, v4, v52
    v_add_f32 v5, v5, v53
    v_add_f32 v4, v4, v54
    v_add_f32 v5, v5, v55
    v_add_f32 v4, v4, v56
    v_add_f32 v5, v5, v57
    v_add_f32 v4, v4, v58
    v_add_f32 v5, v5, v59
    v_add_f32 v4, v4, v5
    s_nop 1
    v_add_f32_dpp v4, v4, v4 quad_perm:[1,0,3,2] row_mask:0xf bank_mask:0xf
    s_nop 1
    v_add_f32_dpp v4, v4, v4 quad_perm:[2,3,0,1] row_mask:0xf bank_mask:0xf
    s_nop 1
    v_add_f32_dpp v4, v4, v4 row_half_mirror row_mask:0xf bank_mask:0xf
    s_nop 1
    v_add_f32_dpp v4, v4, v4 row_mirror row_mask:0xf bank_mask:0xf
    v_mov_b32 v5, v4
    s_nop 1
    v_permlane16_swap_b32 v4, v5
    v_add_f32 v4, v4, v5
    v_mul_f32 v4, 0x3a800000, v4
    v_mov_b32 v6, 0
    v_mov_b32 v7, 0
    v_sub_f32 v8, v28, v4
    v_sub_f32 v9, v29, v4
    v_fmac_f32 v6, v8, v8
    v_fmac_f32 v7, v9, v9
    v_sub_f32 v8, v30, v4
    v_sub_f32 v9, v31, v4
    v_fmac_f32 v6, v8, v8
    v_fmac_f32 v7, v9, v9
    v_sub_f32 v8, v32, v4
    v_sub_f32 v9, v33, v4
    v_fmac_f32 v6, v8, v8
    v_fmac_f32 v7, v9, v9
    v_sub_f32 v8, v34, v4
    v_sub_f32 v9, v35, v4
    v_fmac_f32 v6, v8, v8
    v_fmac_f32 v7, v9, v9
    v_sub_f32 v8, v36, v4
    v_sub_f32 v9, v37, v4
    v_fmac_f32 v6, v8, v8
    v_fmac_f32 v7, v9, v9
    v_sub_f32 v8, v38, v4
    v_sub_f32 v9, v39, v4
    v_fmac_f32 v6, v8, v8
    v_fmac_f32 v7, v9, v9
    v_sub_f32 v8, v40, v4
    v_sub_f32 v9, v41, v4
    v_fmac_f32 v6, v8, v8
    v_fmac_f32 v7, v9, v9
    v_sub_f32 v8, v42, v4
    v_sub_f32 v9, v43, v4
    v_fmac_f32 v6, v8, v8
    v_fmac_f32 v7, v9, v9
    v_sub_f32 v8, v44, v4
    v_sub_f32 v9, v45, v4
    v_fmac_f32 v6, v8, v8
    v_fmac_f32 v7, v9, v9
    v_sub_f32 v8, v46, v4
    v_sub_f32 v9, v47, v4
    v_fmac_f32 v6, v8, v8
    v_fmac_f32 v7, v9, v9
    v_sub_f32 v8, v48, v4
    v_sub_f32 v9, v49, v4
    v_fmac_f32 v6, v8, v8
    v_fmac_f32 v7, v9, v9
    v_sub_f32 v8, v50, v4
    v_sub_f32 v9, v51, v4
    v_fmac_f32 v6, v8, v8
    v_fmac_f32 v7, v9, v9
    v_sub_f32 v8, v52, v4
    v_sub_f32 v9, v53, v4
    v_fmac_f32 v6, v8, v8
    v_fmac_f32 v7, v9, v9
    v_sub_f32 v8, v54, v4
    v_sub_f32 v9, v55, v4
    v_fmac_f32 v6, v8, v8
    v_fmac_f32 v7, v9, v9
    v_sub_f32 v8, v56, v4
    v_sub_f32 v9, v57, v4
    v_fmac_f32 v6, v8, v8
    v_fmac_f32 v7, v9, v9
    v_sub_f32 v8, v58, v4
    v_sub_f32 v9, v59, v4
    v_fmac_f32 v6, v8, v8
    v_fmac_f32 v7, v9, v9
    v_add_f32 v6, v6, v7
    s_nop 1
    v_add_f32_dpp v6, v6, v6 quad_perm:[1,0,3,2] row_mask:0xf bank_mask:0xf
    s_nop 1
    v_add_f32_dpp v6, v6, v6 quad_perm:[2,3,0,1] row_mask:0xf bank_mask:0xf
    s_nop 1
    v_add_f32_dpp v6, v6, v6 row_half_mirror row_mask:0xf bank_mask:0xf
    s_nop 1
    v_add_f32_dpp v6, v6, v6 row_mirror row_mask:0xf bank_mask:0xf
    v_mov_b32 v7, v6
    s_nop 1
    v_permlane16_swap_b32 v6, v7
    v_add_f32 v6, v6, v7
    v_mul_f32 v6, 0x3a800000, v6
    v_cvt_pk_bf16_f32 v5, v4, v6
    v_lshlrev_b32 v4, 16, v5
    v_and_b32 v6, 0xffff0000, v5
    v_add_f32 v6, 0x3727c5ac, v6
    v_cvt_pk_bf16_f32 v6, v6, v6
    v_lshlrev_b32 v6, 16, v6
    v_sqrt_f32 v6, v6
    s_nop 0
    v_cvt_pk_bf16_f32 v6, v6, v6
    v_lshlrev_b32 v6, 16, v6
    v_rcp_f32 v6, v6
    v_sub_f32 v8, v28, v4
    v_sub_f32 v9, v29, v4
    v_cvt_pk_bf16_f32 v8, v8, v9
    v_and_b32 v9, 0xffff0000, v8
    v_lshlrev_b32 v8, 16, v8
    v_mul_f32 v8, v8, v6
    v_mul_f32 v9, v9, v6
    v_cvt_pk_bf16_f32 v12, v8, v9
    v_sub_f32 v8, v30, v4
    v_sub_f32 v9, v31, v4
    v_cvt_pk_bf16_f32 v8, v8, v9
    v_and_b32 v9, 0xffff0000, v8
    v_lshlrev_b32 v8, 16, v8
    v_mul_f32 v8, v8, v6
    v_mul_f32 v9, v9, v6
    v_cvt_pk_bf16_f32 v13, v8, v9
    v_sub_f32 v8, v32, v4
    v_sub_f32 v9, v33, v4
    v_cvt_pk_bf16_f32 v8, v8, v9
    v_and_b32 v9, 0xffff0000, v8
    v_lshlrev_b32 v8, 16, v8
    v_mul_f32 v8, v8, v6
    v_mul_f32 v9, v9, v6
    v_cvt_pk_bf16_f32 v14, v8, v9
    v_sub_f32 v8, v34, v4
    v_sub_f32 v9, v35, v4
    v_cvt_pk_bf16_f32 v8, v8, v9
    v_and_b32 v9, 0xffff0000, v8
    v_lshlrev_b32 v8, 16, v8
    v_mul_f32 v8, v8, v6
    v_mul_f32 v9, v9, v6
    v_cvt_pk_bf16_f32 v15, v8, v9
    v_sub_f32 v8, v36, v4
    v_sub_f32 v9, v37, v4
    v_cvt_pk_bf16_f32 v8, v8, v9
    v_and_b32 v9, 0xffff0000, v8
    v_lshlrev_b32 v8, 16, v8
    v_mul_f32 v8, v8, v6
    v_mul_f32 v9, v9, v6
    v_cvt_pk_bf16_f32 v16, v8, v9
    v_sub_f32 v8, v38, v4
    v_sub_f32 v9, v39, v4
    v_cvt_pk_bf16_f32 v8, v8, v9
    v_and_b32 v9, 0xffff0000, v8
    v_lshlrev_b32 v8, 16, v8
    v_mul_f32 v8, v8, v6
    v_mul_f32 v9, v9, v6
    v_cvt_pk_bf16_f32 v17, v8, v9
    v_sub_f32 v8, v40, v4
    v_sub_f32 v9, v41, v4
    v_cvt_pk_bf16_f32 v8, v8, v9
    v_and_b32 v9, 0xffff0000, v8
    v_lshlrev_b32 v8, 16, v8
    v_mul_f32 v8, v8, v6
    v_mul_f32 v9, v9, v6
    v_cvt_pk_bf16_f32 v18, v8, v9
    v_sub_f32 v8, v42, v4
    v_sub_f32 v9, v43, v4
    v_cvt_pk_bf16_f32 v8, v8, v9
    v_and_b32 v9, 0xffff0000, v8
    v_lshlrev_b32 v8, 16, v8
    v_mul_f32 v8, v8, v6
    v_mul_f32 v9, v9, v6
    v_cvt_pk_bf16_f32 v19, v8, v9
    v_sub_f32 v8, v44, v4
    v_sub_f32 v9, v45, v4
    v_cvt_pk_bf16_f32 v8, v8, v9
    v_and_b32 v9, 0xffff0000, v8
    v_lshlrev_b32 v8, 16, v8
    v_mul_f32 v8, v8, v6
    v_mul_f32 v9, v9, v6
    v_cvt_pk_bf16_f32 v20, v8, v9
    v_sub_f32 v8, v46, v4
    v_sub_f32 v9, v47, v4
    v_cvt_pk_bf16_f32 v8, v8, v9
    v_and_b32 v9, 0xffff0000, v8
    v_lshlrev_b32 v8, 16, v8
    v_mul_f32 v8, v8, v6
    v_mul_f32 v9, v9, v6
    v_cvt_pk_bf16_f32 v21, v8, v9
    v_sub_f32 v8, v48, v4
    v_sub_f32 v9, v49, v4
    v_cvt_pk_bf16_f32 v8, v8, v9
    v_and_b32 v9, 0xffff0000, v8
    v_lshlrev_b32 v8, 16, v8
    v_mul_f32 v8, v8, v6
    v_mul_f32 v9, v9, v6
    v_cvt_pk_bf16_f32 v22, v8, v9
    v_sub_f32 v8, v50, v4
    v_sub_f32 v9, v51, v4
    v_cvt_pk_bf16_f32 v8, v8, v9
    v_and_b32 v9, 0xffff0000, v8
    v_lshlrev_b32 v8, 16, v8
    v_mul_f32 v8, v8, v6
    v_mul_f32 v9, v9, v6
    v_cvt_pk_bf16_f32 v23, v8, v9
    v_sub_f32 v8, v52, v4
    v_sub_f32 v9, v53, v4
    v_cvt_pk_bf16_f32 v8, v8, v9
    v_and_b32 v9, 0xffff0000, v8
    v_lshlrev_b32 v8, 16, v8
    v_mul_f32 v8, v8, v6
    v_mul_f32 v9, v9, v6
    v_cvt_pk_bf16_f32 v24, v8, v9
    v_sub_f32 v8, v54, v4
    v_sub_f32 v9, v55, v4
    v_cvt_pk_bf16_f32 v8, v8, v9
    v_and_b32 v9, 0xffff0000, v8
    v_lshlrev_b32 v8, 16, v8
    v_mul_f32 v8, v8, v6
    v_mul_f32 v9, v9, v6
    v_cvt_pk_bf16_f32 v25, v8, v9
    v_sub_f32 v8, v56, v4
    v_sub_f32 v9, v57, v4
    v_cvt_pk_bf16_f32 v8, v8, v9
    v_and_b32 v9, 0xffff0000, v8
    v_lshlrev_b32 v8, 16, v8
    v_mul_f32 v8, v8, v6
    v_mul_f32 v9, v9, v6
    v_cvt_pk_bf16_f32 v26, v8, v9
    v_sub_f32 v8, v58, v4
    v_sub_f32 v9, v59, v4
    v_cvt_pk_bf16_f32 v8, v8, v9
    v_and_b32 v9, 0xffff0000, v8
    v_lshlrev_b32 v8, 16, v8
    v_mul_f32 v8, v8, v6
    v_mul_f32 v9, v9, v6
    v_cvt_pk_bf16_f32 v27, v8, v9
    v_lshrrev_b32 v4, 5, v0
    s_lshl_b32 s5, s3, 1
    v_add_u32 v4, s5, v4
    v_mul_u32_u24 v4, 2064, v4
    v_and_b32 v5, 31, v0
    v_lshl_add_u32 v4, v5, 4, v4
    ds_write_b128 v4, v[12:15] offset:6400
    ds_write_b128 v4, v[16:19] offset:6912
    ds_write_b128 v4, v[20:23] offset:7424
    ds_write_b128 v4, v[24:27] offset:7936
    s_cmp_lg_u32 s3, 0
    s_cbranch_scc1 L_ln2
    s_waitcnt vmcnt(0)
L_ln2:
    v_mov_b32 v3, 6272
    v_mov_b32 v4, 1
    s_mov_b64 exec, 1
    ds_add_u32 v3, v4 offset:0
    s_mov_b64 exec, -1
    s_cmp_lg_u32 s3, 0
    s_cbranch_scc1 L_clrb
    s_and_b32 s6, s2, 15
    s_lshl_b32 s6, s6, 2
    s_bfe_u32 s7, s2, 0x10004
    s_lshl_b32 s7, s7, 7
    s_add_u32 s6, s6, s7
    v_mov_b32 v4, 0x1
    s_mov_b64 exec, 1
    buffer_atomic_add v4, off, s[68:71], s6 offset:64 sc1
    s_mov_b64 exec, -1
    s_cmp_lg_u32 s2, 248
    s_cbranch_scc1 L_arrb
    v_and_b32 v3, 15, v0
    v_lshlrev_b32 v3, 2, v3
    v_bfe_u32 v4, v0, 4, 1
    v_lshl_add_u32 v3, v4, 7, v3
    v_add_u32 v3, 64, v3
    v_and_b32 v4, 32, v0
    v_lshlrev_b32 v4, 1, v4
    v_sub_u32 v3, v3, v4
    s_mov_b32 s86, 131072
    s_mov_b32 s4, 0x8
    s_sleep 80
L_rba_p:
    buffer_load_dword v4, v3, s[68:71], 0 offen sc1
    s_waitcnt vmcnt(0)
    v_and_b32 v5, 0xff, v4
    v_cmp_ne_u32 vcc, s4, v5
    s_nop 0
    s_cmp_eq_u32 vcc_lo, 0
    s_nop 1
    s_cbranch_scc1 L_rba_d
    s_sleep 10
    s_sub_u32 s86, s86, 1
    s_cmp_lg_u32 s86, 0
    s_cbranch_scc1 L_rba_p
L_rba_d:
    s_add_u32 s4, s100, -30
    v_subrev_u32 v4, s100, v4
    v_max_i32 v4, -300, v4
    v_min_i32 v4, 300, v4
    v_mov_b32 v6, v4
    s_nop 1
    v_max_i32_dpp v6, v6, v6 quad_perm:[1,0,3,2] row_mask:0xf bank_mask:0xf
    s_nop 1
    v_max_i32_dpp v6, v6, v6 quad_perm:[2,3,0,1] row_mask:0xf bank_mask:0xf
    s_nop 1
    v_max_i32_dpp v6, v6, v6 row_half_mirror row_mask:0xf bank_mask:0xf
    s_nop 1
    v_max_i32_dpp v6, v6, v6 row_mirror row_mask:0xf bank_mask:0xf
    v_mov_b32 v5, v6
    s_nop 1
    v_permlane16_swap_b32 v6, v5
    v_max_i32 v6, v6, v5
    v_add_u32_dpp v4, v4, v4 quad_perm:[1,0,3,2] row_mask:0xf bank_mask:0xf
    s_nop 1
    v_add_u32_dpp v4, v4, v4 quad_perm:[2,3,0,1] row_mask:0xf bank_mask:0xf
    s_nop 1
    v_add_u32_dpp v4, v4, v4 row_half_mirror row_mask:0xf bank_mask:0xf
    s_nop 1
    v_add_u32_dpp v4, v4, v4 row_mirror row_mask:0xf bank_mask:0xf
    v_mov_b32 v5, v4
    s_nop 1
    v_permlane16_swap_b32 v4, v5
    v_add_u32 v4, v4, v5
    s_nop 0
    v_readlane_b32 s5, v4, 32
    s_nop 0
    s_ashr_i32 s5, s5, 5
    v_readlane_b32 s6, v6, 32
    s_nop 0
    s_sub_i32 s6, s6, s5
    s_mul_i32 s6, s6, 2
    s_ashr_i32 s6, s6, 2
    s_add_u32 s5, s5, s6
    s_add_u32 s4, s4, s5
    s_andn2_b32 s4, s4, 3
    s_or_b32 s4, s4, 1
    v_mov_b32 v60, s4
    v_mov_b32 v56, s4
    v_mov_b32 v57, s4
    v_mov_b32 v58, s4
    v_mov_b32 v59, s4
    v_lshlrev_b32 v3, 7, v0
    s_mov_b32 s4, 0x380000
    buffer_store_dwordx4 v[56:59], v3, s[60:63], s4 offen sc1
    v_mov_b32 v3, 6272
    s_mov_b64 exec, 1
    ds_write_b32 v3, v60 offset:24
    s_mov_b64 exec, -1
    v_mov_b32 v3, 6272
    v_mov_b32 v4, 0x200
    s_mov_b64 exec, 1
    ds_add_u32 v3, v4 offset:8
    s_mov_b64 exec, -1
    s_branch L_arrb
L_clrb:
    s_setprio 0
    s_lshl_b32 s7, s78, 12
    s_add_u32 s7, s7, 0x200000
    s_lshl_b32 s8, s2, 13
    s_lshl_b32 s9, s3, 12
    s_add_u32 s8, s8, s9
    s_add_u32 s8, s8, 0x3fe000
    s_cmp_eq_u32 s3, 1
    s_cselect_b32 s7, s7, s8
    buffer_store_dwordx4 v[60:63], v2, s[60:63], s7 offen offset:0 sc1
    buffer_store_dwordx4 v[60:63], v2, s[60:63], s7 offen offset:1024 sc1
    buffer_store_dwordx4 v[60:63], v2, s[60:63], s7 offen offset:2048 sc1
    buffer_store_dwordx4 v[60:63], v2, s[60:63], s7 offen offset:3072 sc1
    s_nop 0
    s_branch L_arrb
L_p1:
    s_cmp_lt_u32 s3, 8
    s_cbranch_scc1 L_p1go
    s_cmp_lt_u32 s2, 224
    s_cbranch_scc1 L_p1go
    s_cmp_lg_u32 s3, 9
    s_cbranch_scc1 L_kload
    s_getpc_b64 s[6:7]
L_pc:
    v_lshlrev_b32 v6, 6, v0
    v_min_u32 v4, L_end-L_pc, v6
    global_load_dword v60, v4, s[6:7]
    v_add_u32 v6, 4096, v6
    v_min_u32 v4, L_end-L_pc, v6
    global_load_dword v61, v4, s[6:7]
    v_add_u32 v6, 4096, v6
    v_min_u32 v4, L_end-L_pc, v6
    global_load_dword v62, v4, s[6:7]
    v_add_u32 v6, 4096, v6
    v_min_u32 v4, L_end-L_pc, v6
    global_load_dword v63, v4, s[6:7]
    v_add_u32 v6, 4096, v6
    v_min_u32 v4, L_end-L_pc, v6
    global_load_dword v60, v4, s[6:7]
    s_branch L_kload
L_p1go:
    v_and_b32 v3, 7, v0
    v_mul_u32_u24 v3, 2064, v3
    v_bfe_u32 v4, v0, 3, 1
    v_lshl_add_u32 v3, v4, 6, v3
    v_lshrrev_b32 v5, 4, v0
    v_lshl_add_u32 v3, v5, 4, v3
    s_lshl_b32 s4, s96, 1
    v_add_u32 v3, s4, v3
    v_lshrrev_b32 v6, 5, v0
    s_lshl_b32 s5, s3, 1
    s_sub_u32 s5, s5, 8
    v_add_u32 v7, s5, v6
    v_mul_u32_u24 v7, 2176, v7
    v_and_b32 v8, 7, v0
    v_mul_u32_u24 v8, 272, v8
    v_add_u32 v7, v7, v8
    v_bfe_u32 v8, v0, 4, 1
    s_cmp_lt_u32 s3, 8
    s_cselect_b32 s5, 7, 4
    v_lshlrev_b32 v8, s5, v8
    v_add_u32 v7, v7, v8
    v_add_u32 v7, 22912, v7
    v_cmp_eq_u32 vcc, v4, v6
    v_mov_b32 v8, 0
    s_nop 0
    v_cndmask_b32 v7, v8, v7, vcc
    v_mov_b32 v8, 6272
    s_mov_b32 s86, 2097152
L_sp_1:
    ds_read_b32 v9, v8 offset:0
    s_waitcnt lgkmcnt(0)
    v_cmp_ne_u32 vcc, 0x4, v9
    s_nop 3
    s_cbranch_vccz L_sp_2
    s_sleep 1
    s_sub_u32 s86, s86, 1
    s_cmp_lg_u32 s86, 0
    s_cbranch_scc1 L_sp_1
L_sp_2:
    ds_read_b128 v[44:47], v3 offset:6400
    s_waitcnt vmcnt(0) lgkmcnt(0)
    v_perm_b32 v64, v16, v12, s72
    v_perm_b32 v65, v24, v20, s72
    v_perm_b32 v66, v32, v28, s72
    v_perm_b32 v67, v40, v36, s72
    v_perm_b32 v68, v16, v12, s73
    v_perm_b32 v69, v24, v20, s73
    v_perm_b32 v70, v32, v28, s73
    v_perm_b32 v71, v40, v36, s73
    v_perm_b32 v80, v17, v13, s72
    v_perm_b32 v81, v25, v21, s72
    v_perm_b32 v82, v33, v29, s72
    v_perm_b32 v83, v41, v37, s72
    v_perm_b32 v84, v17, v13, s73
    v_perm_b32 v85, v25, v21, s73
    v_perm_b32 v86, v33, v29, s73
    v_perm_b32 v87, v41, v37, s73
    v_perm_b32 v96, v18, v14, s72
    v_perm_b32 v97, v26, v22, s72
    v_perm_b32 v98, v34, v30, s72
    v_perm_b32 v99, v42, v38, s72
    v_perm_b32 v100, v18, v14, s73
    v_perm_b32 v101, v26, v22, s73
    v_perm_b32 v102, v34, v30, s73
    v_perm_b32 v103, v42, v38, s73
    v_perm_b32 v112, v19, v15, s72
    v_perm_b32 v113, v27, v23, s72
    v_perm_b32 v114, v35, v31, s72
    v_perm_b32 v115, v43, v39, s72
    v_perm_b32 v116, v19, v15, s73
    v_perm_b32 v117, v27, v23, s73
    v_perm_b32 v118, v35, v31, s73
    v_perm_b32 v119, v43, v39, s73
    s_cmp_ge_u32 s3, 8
    s_cbranch_scc1 L_p1gu
    v_mfma_f32_16x16x32_bf16 v[72:75], v[64:67], v[44:47], 0
    v_mfma_f32_16x16x32_bf16 v[76:79], v[68:71], v[44:47], 0
    v_mfma_f32_16x16x32_bf16 v[88:91], v[80:83], v[44:47], 0
    v_mfma_f32_16x16x32_bf16 v[92:95], v[84:87], v[44:47], 0
    v_mfma_f32_16x16x32_bf16 v[104:107], v[96:99], v[44:47], 0
    v_mfma_f32_16x16x32_bf16 v[108:111], v[100:103], v[44:47], 0
    v_mfma_f32_16x16x32_bf16 v[120:123], v[112:115], v[44:47], 0
    v_mfma_f32_16x16x32_bf16 v[124:127], v[116:119], v[44:47], 0
    s_nop 1
    ds_write2_b32 v7, v72, v76 offset0:0 offset1:1
    ds_write2_b32 v7, v73, v77 offset0:8 offset1:9
    ds_write2_b32 v7, v74, v78 offset0:16 offset1:17
    ds_write2_b32 v7, v75, v79 offset0:24 offset1:25
    ds_write2_b32 v7, v88, v92 offset0:2 offset1:3
    ds_write2_b32 v7, v89, v93 offset0:10 offset1:11
    ds_write2_b32 v7, v90, v94 offset0:18 offset1:19
    ds_write2_b32 v7, v91, v95 offset0:26 offset1:27
    ds_write2_b32 v7, v104, v108 offset0:4 offset1:5
    ds_write2_b32 v7, v105, v109 offset0:12 offset1:13
    ds_write2_b32 v7, v106, v110 offset0:20 offset1:21
    ds_write2_b32 v7, v107, v111 offset0:28 offset1:29
    ds_write2_b32 v7, v120, v124 offset0:6 offset1:7
    ds_write2_b32 v7, v121, v125 offset0:14 offset1:15
    ds_write2_b32 v7, v122, v126 offset0:22 offset1:23
    ds_write2_b32 v7, v123, v127 offset0:30 offset1:31
    s_branch L_p1j
L_p1gu:
    v_mfma_f32_16x16x32_bf16 v[72:75], v[44:47], v[64:67], 0
    v_mfma_f32_16x16x32_bf16 v[76:79], v[44:47], v[68:71], 0
    v_mfma_f32_16x16x32_bf16 v[88:91], v[44:47], v[80:83], 0
    v_mfma_f32_16x16x32_bf16 v[92:95], v[44:47], v[84:87], 0
    v_mfma_f32_16x16x32_bf16 v[104:107], v[44:47], v[96:99], 0
    v_mfma_f32_16x16x32_bf16 v[108:111], v[44:47], v[100:103], 0
    v_mfma_f32_16x16x32_bf16 v[120:123], v[44:47], v[112:115], 0
    v_mfma_f32_16x16x32_bf16 v[124:127], v[44:47], v[116:119], 0
    s_nop 0
    ds_write_b128 v7, v[72:75] offset:0
    ds_write_b128 v7, v[76:79] offset:32
    ds_write_b128 v7, v[88:91] offset:64
    ds_write_b128 v7, v[92:95] offset:96
    ds_write_b128 v7, v[104:107] offset:128
    ds_write_b128 v7, v[108:111] offset:160
    ds_write_b128 v7, v[120:123] offset:192
    ds_write_b128 v7, v[124:127] offset:224
L_p1j:
    s_lshl_b32 s8, s88, 2
    s_add_u32 s8, s8, 6320
    v_mov_b32 v3, s8
    v_mov_b32 v4, 1
    s_mov_b64 exec, 1
    ds_add_rtn_u32 v4, v3, v4 offset:0
    s_mov_b64 exec, -1
    s_waitcnt lgkmcnt(0)
    v_readfirstlane_b32 s8, v4
    s_nop 0
    s_cmp_lg_u32 s8, 3
    s_nop 1
    s_cbranch_scc1 L_kload
    s_setprio 3
    v_lshrrev_b32 v3, 4, v0
    v_mul_u32_u24 v3, 272, v3
    v_and_b32 v4, 15, v0
    v_lshl_add_u32 v3, v4, 4, v3
    s_mul_i32 s8, s88, 17408
    s_add_u32 s8, s8, 22912
    v_add_u32 v3, s8, v3
    ds_read_b128 v[64:67], v3 offset:0
    ds_read_b128 v[68:71], v3 offset:2176
    ds_read_b128 v[72:75], v3 offset:4352
    ds_read_b128 v[76:79], v3 offset:6528
    ds_read_b128 v[80:83], v3 offset:8704
    ds_read_b128 v[84:87], v3 offset:10880
    ds_read_b128 v[88:91], v3 offset:13056
    ds_read_b128 v[92:95], v3 offset:15232
    ds_read_b128 v[96:99], v3 offset:1088
    ds_read_b128 v[100:103], v3 offset:3264
    ds_read_b128 v[104:107], v3 offset:5440
    ds_read_b128 v[108:111], v3 offset:7616
    ds_read_b128 v[112:115], v3 offset:9792
    ds_read_b128 v[116:119], v3 offset:11968
    ds_read_b128 v[120:123], v3 offset:14144
    ds_read_b128 v[124:127], v3 offset:16320
    v_and_b32 v4, 15, v0
    v_lshrrev_b32 v6, 4, v0
    v_lshlrev_b32 v6, 14, v6
    v_lshl_add_u32 v6, v4, 4, v6
    s_lshl_b32 s4, s82, 9
    s_add_u32 s4, s4, s83
    s_lshl_b32 s4, s4, 8
    s_mul_i32 s5, s98, 114688
    s_lshl_b32 s6, s97, 11
    s_add_u32 s5, s5, s6
    s_lshl_b32 s6, s88, 19
    s_add_u32 s5, s5, s6
    s_movk_i32 s10, 1024
    s_cmp_eq_u32 s88, 0
    s_cselect_b32 s4, s4, s5
    s_cselect_b32 s10, 0x10000, s10
    s_cselect_b64 vcc, -1, 0
    v_cndmask_b32 v6, v2, v6, vcc
    s_waitcnt lgkmcnt(8)
    v_add_f32 v64, v64, v68
    v_add_f32 v65, v65, v69
    v_add_f32 v66, v66, v70
    v_add_f32 v67, v67, v71
    v_add_f32 v72, v72, v76
    v_add_f32 v73, v73, v77
    v_add_f32 v74, v74, v78
    v_add_f32 v75, v75, v79
    v_add_f32 v80, v80, v84
    v_add_f32 v81, v81, v85
    v_add_f32 v82, v82, v86
    v_add_f32 v83, v83, v87
    v_add_f32 v88, v88, v92
    v_add_f32 v89, v89, v93
    v_add_f32 v90, v90, v94
    v_add_f32 v91, v91, v95
    v_add_f32 v64, v64, v72
    v_add_f32 v65, v65, v73
    v_add_f32 v66, v66, v74
    v_add_f32 v67, v67, v75
    v_add_f32 v80, v80, v88
    v_add_f32 v81, v81, v89
    v_add_f32 v82, v82, v90
    v_add_f32 v83, v83, v91
    v_add_f32 v12, v64, v80
    v_add_f32 v13, v65, v81
    v_add_f32 v14, v66, v82
    v_add_f32 v15, v67, v83
    v_min_u32 v12, -2, v12
    v_min_u32 v13, -2, v13
    v_min_u32 v14, -2, v14
    v_min_u32 v15, -2, v15
    buffer_store_dwordx4 v[12:15], v6, s[60:63], s4 offen sc1
    s_add_u32 s4, s4, s10
    s_waitcnt lgkmcnt(0)
    v_add_f32 v96, v96, v100
    v_add_f32 v97, v97, v101
    v_add_f32 v98, v98, v102
    v_add_f32 v99, v99, v103
    v_add_f32 v104, v104, v108
    v_add_f32 v105, v105, v109
    v_add_f32 v106, v106, v110
    v_add_f32 v107, v107, v111
    v_add_f32 v112, v112, v116
    v_add_f32 v113, v113, v117
    v_add_f32 v114, v114, v118
    v_add_f32 v115, v115, v119
    v_add_f32 v120, v120, v124
    v_add_f32 v121, v121, v125
    v_add_f32 v122, v122, v126
    v_add_f32 v123, v123, v127
    v_add_f32 v96, v96, v104
    v_add_f32 v97, v97, v105
    v_add_f32 v98, v98, v106
    v_add_f32 v99, v99, v107
    v_add_f32 v112, v112, v120
    v_add_f32 v113, v113, v121
    v_add_f32 v114, v114, v122
    v_add_f32 v115, v115, v123
    v_add_f32 v16, v96, v112
    v_add_f32 v17, v97, v113
    v_add_f32 v18, v98, v114
    v_add_f32 v19, v99, v115
    v_min_u32 v16, -2, v16
    v_min_u32 v17, -2, v17
    v_min_u32 v18, -2, v18
    v_min_u32 v19, -2, v19
    buffer_store_dwordx4 v[16:19], v6, s[60:63], s4 offen sc1
    s_cmp_eq_u32 s88, 0
    s_cselect_b32 s4, 0x101, 1
    v_mov_b32 v3, 6272
    v_mov_b32 v4, s4
    s_mov_b64 exec, 1
    ds_add_u32 v3, v4 offset:8
    s_mov_b64 exec, -1
    s_cmp_eq_u32 s88, 0
    s_cbranch_scc1 L_kload
L_arrb:
    s_waitcnt vmcnt(0)
    v_mov_b32 v3, 6272
    v_mov_b32 v4, 1
    s_mov_b64 exec, 1
    ds_add_rtn_u32 v4, v3, v4 offset:44
    s_mov_b64 exec, -1
    s_waitcnt lgkmcnt(0)
    v_readfirstlane_b32 s8, v4
    s_cmp_lt_u32 s2, 224
    s_cselect_b32 s9, 5, 3
    s_cmp_lg_u32 s8, s9
    s_nop 0
    s_cbranch_scc1 L_kload
    s_setprio 3
    s_and_b32 s6, s2, 15
    s_lshl_b32 s6, s6, 2
    s_bfe_u32 s7, s2, 0x10004
    s_lshl_b32 s7, s7, 7
    s_add_u32 s6, s6, s7
    v_mov_b32 v4, 0x100
    s_mov_b64 exec, 1
    buffer_atomic_add v4, off, s[68:71], s6 offset:64 sc1
    s_mov_b64 exec, -1
L_kload:
    s_cmp_lt_u32 s3, 4
    s_cbranch_scc1 L_comm
    s_setprio 0
    s_movk_i32 s4, 0x3
    s_cmp_lt_u32 s3, 8
    s_cselect_b32 s4, 0x80100, s4
    s_cmp_lt_u32 s2, 224
    s_cselect_b32 s4, s4, 0x100
    s_cmp_eq_u32 s2, 248
    s_cselect_b32 s4, 0x300, s4
    v_mov_b32 v3, 6272
    s_mov_b32 s86, 2097152
L_sp_3:
    ds_read_b32 v4, v3 offset:8
    s_waitcnt lgkmcnt(0)
    v_and_b32 v4, s4, v4
    v_cmp_ne_u32 vcc, s4, v4
    s_nop 3
    s_cbranch_vccz L_sp_4
    s_sleep 1
    s_sub_u32 s86, s86, 1
    s_cmp_lg_u32 s86, 0
    s_cbranch_scc1 L_sp_3
L_sp_4:
L_pc_5:
    s_memrealtime s[14:15]
    s_waitcnt lgkmcnt(0)
    s_sub_u32 s15, s90, s14
    s_sub_u32 s15, s15, 1
    s_cmp_ge_u32 s15, 8000
    s_cbranch_scc1 L_pc_6
    s_cmp_ge_u32 s15, 40
    s_cbranch_scc1 L_pc_7
    s_sleep 1
    s_branch L_pc_5
L_pc_7:
    s_sleep 8
    s_branch L_pc_5
L_pc_6:
    s_cmp_ge_u32 s3, 8
    s_cbranch_scc1 L_nowd
    s_mov_b32 s56, s32
    s_and_b32 s57, s33, 0xffff
    s_mov_b32 s58, 0x700000
    s_mov_b32 s59, 0x00020000
    v_lshrrev_b32 v4, 3, v0
    v_lshlrev_b32 v3, 11, v4
    v_and_b32 v4, 2, v4
    v_and_b32 v5, 7, v0
    v_xor_b32 v5, v4, v5
    v_lshl_add_u32 v3, v5, 4, v3
    v_xor_b32 v4, 64, v3
    s_mul_i32 s8, s83, 114688
    s_lshl_b32 s9, s82, 9
    s_add_u32 s8, s8, s9
    s_sub_u32 s9, s3, 4
    s_lshl_b32 s10, s9, 11
    s_add_u32 s10, s10, 75776
    s_lshl_b32 s11, s9, 15
    s_add_u32 s8, s8, s11
    s_add_u32 s11, s8, 0
    s_add_u32 m0, s10, 0
    s_nop 0
    buffer_load_dwordx4 v3, s[56:59], s11 offen nt lds
    s_add_u32 s11, s8, 128
    s_add_u32 m0, s10, 16384
    s_nop 0
    buffer_load_dwordx4 v3, s[56:59], s11 offen nt lds
    s_add_u32 s11, s8, 256
    s_add_u32 m0, s10, 32768
    s_nop 0
    buffer_load_dwordx4 v3, s[56:59], s11 offen nt lds
    s_add_u32 s11, s8, 384
    s_add_u32 m0, s10, 49152
    s_nop 0
    buffer_load_dwordx4 v3, s[56:59], s11 offen nt lds
    s_cmp_eq_u32 s9, 3
    s_cbranch_scc1 L_twe_8
    s_add_u32 s11, s8, 16384
    s_add_u32 m0, s10, 1024
    s_nop 0
    buffer_load_dwordx4 v4, s[56:59], s11 offen nt lds
    s_add_u32 s11, s8, 16512
    s_add_u32 m0, s10, 17408
    s_nop 0
    buffer_load_dwordx4 v4, s[56:59], s11 offen nt lds
    s_add_u32 s11, s8, 16640
    s_add_u32 m0, s10, 33792
    s_nop 0
    buffer_load_dwordx4 v4, s[56:59], s11 offen nt lds
    s_add_u32 s11, s8, 16768
    s_add_u32 m0, s10, 50176
    s_nop 0
    buffer_load_dwordx4 v4, s[56:59], s11 offen nt lds
L_twe_8:
    s_branch L_nowd
L_comm:
    s_setprio 3
    s_cmp_lg_u32 s3, 0
    s_cbranch_scc1 L_mb_lds
    s_cmp_eq_u32 s2, 248
    s_cbranch_scc1 L_mb_done
    s_sleep 80
    s_mov_b32 s86, 131072
    s_mov_b64 exec, 1
L_mba_p:
    buffer_load_dword v60, off, s[60:63], s101 sc1
    s_waitcnt vmcnt(0)
    v_cmp_eq_u32 vcc, -1, v60
    s_nop 3
    s_cbranch_vccz L_mba_d
    s_sleep 6
    s_sub_u32 s86, s86, 1
    s_cmp_lg_u32 s86, 0
    s_cbranch_scc1 L_mba_p
L_mba_d:
    s_mov_b64 exec, -1
    v_mov_b32 v3, 6272
    s_mov_b64 exec, 1
    ds_write_b32 v3, v60 offset:24
    s_mov_b64 exec, -1
    v_mov_b32 v3, 6272
    v_mov_b32 v4, 0x200
    s_mov_b64 exec, 1
    ds_add_u32 v3, v4 offset:8
    s_mov_b64 exec, -1
    s_branch L_mb_done
L_mb_lds:
    v_mov_b32 v3, 6272
    s_mov_b32 s86, 2097152
L_sp_9:
    ds_read_b32 v4, v3 offset:8
    s_waitcnt lgkmcnt(0)
    v_and_b32 v4, 0x200, v4
    v_cmp_ne_u32 vcc, 0x200, v4
    s_nop 3
    s_cbranch_vccz L_sp_10
    s_sleep 1
    s_sub_u32 s86, s86, 1
    s_cmp_lg_u32 s86, 0
    s_cbranch_scc1 L_sp_9
L_sp_10:
L_mb_done:
    s_mul_i32 s8, s81, 70
    s_add_u32 s8, s8, 500
    s_add_u32 s8, s8, s100
L_pc_11:
    s_memrealtime s[14:15]
    s_waitcnt lgkmcnt(0)
    s_sub_u32 s15, s8, s14
    s_sub_u32 s15, s15, 1
    s_cmp_ge_u32 s15, 8000
    s_cbranch_scc1 L_pc_12
    s_cmp_ge_u32 s15, 40
    s_cbranch_scc1 L_pc_13
    s_sleep 1
    s_branch L_pc_11
L_pc_13:
    s_sleep 8
    s_branch L_pc_11
L_pc_12:
    s_lshl_b32 s4, s79, 14
    s_lshl_b32 s5, s80, 12
    s_add_u32 s4, s4, s5
    s_lshl_b32 s5, s3, 10
    s_add_u32 s4, s4, s5
    s_add_u32 s4, s4, 0x0
    s_add_u32 s5, s4, 131072
    s_add_u32 s6, s4, 262144
    s_add_u32 s7, s4, 393216
    v_lshrrev_b32 v3, 5, v0
    v_mul_u32_u24 v3, 272, v3
    v_and_b32 v4, 31, v0
    v_lshl_add_u32 v3, v4, 3, v3
    s_mul_i32 s8, s3, 544
    v_add_u32 v3, s8, v3
    buffer_load_dwordx4 v[12:15], v2, s[60:63], s4 offen sc1
    buffer_load_dwordx4 v[16:19], v2, s[60:63], s5 offen sc1
    buffer_load_dwordx4 v[20:23], v2, s[60:63], s6 offen sc1
    buffer_load_dwordx4 v[24:27], v2, s[60:63], s7 offen sc1
    s_mov_b32 s86, 131072
L_vg_14:
    s_waitcnt vmcnt(0)
    v_max3_u32 v5, v12, v13, v14
    v_max3_u32 v6, v15, v16, v17
    v_max3_u32 v5, v5, v18, v19
    v_max3_u32 v6, v6, v20, v21
    v_max3_u32 v5, v5, v22, v23
    v_max3_u32 v6, v6, v24, v25
    v_max3_u32 v5, v5, v26, v27
    v_max_u32 v5, v5, v6
    v_cmp_eq_u32 vcc, -1, v5
    s_nop 3
    s_cbranch_vccz L_vg_15
    s_sub_u32 s86, s86, 1
    s_cmp_eq_u32 s86, 0
    s_cbranch_scc1 L_vg_15
    v_max3_u32 v5, v12, v13, v14
    v_max_u32 v5, v5, v15
    v_cmp_eq_u32 vcc, -1, v5
    s_nop 3
    s_cbranch_vccz L_vs_16
    buffer_load_dwordx4 v[12:15], v2, s[60:63], s4 offen sc1
L_vs_16:
    v_max3_u32 v5, v16, v17, v18
    v_max_u32 v5, v5, v19
    v_cmp_eq_u32 vcc, -1, v5
    s_nop 3
    s_cbranch_vccz L_vs_17
    buffer_load_dwordx4 v[16:19], v2, s[60:63], s5 offen sc1
L_vs_17:
    v_max3_u32 v5, v20, v21, v22
    v_max_u32 v5, v5, v23
    v_cmp_eq_u32 vcc, -1, v5
    s_nop 3
    s_cbranch_vccz L_vs_18
    buffer_load_dwordx4 v[20:23], v2, s[60:63], s6 offen sc1
L_vs_18:
    v_max3_u32 v5, v24, v25, v26
    v_max_u32 v5, v5, v27
    v_cmp_eq_u32 vcc, -1, v5
    s_nop 3
    s_cbranch_vccz L_vs_19
    buffer_load_dwordx4 v[24:27], v2, s[60:63], s7 offen sc1
L_vs_19:
    s_branch L_vg_14
L_vg_15:
    v_add_f32 v12, v12, v16
    v_add_f32 v20, v20, v24
    v_add_f32 v13, v13, v17
    v_add_f32 v21, v21, v25
    v_add_f32 v14, v14, v18
    v_add_f32 v22, v22, v26
    v_add_f32 v15, v15, v19
    v_add_f32 v23, v23, v27
    v_add_f32 v12, v12, v20
    v_add_f32 v13, v13, v21
    v_add_f32 v14, v14, v22
    v_add_f32 v15, v15, v23
    v_cvt_pk_bf16_f32 v12, v12, v13
    v_cvt_pk_bf16_f32 v13, v14, v15
    ds_write_b64 v3, v[12:13] offset:512
    v_mov_b32 v3, 6272
    v_mov_b32 v4, 1
    s_mov_b64 exec, 1
    ds_add_u32 v3, v4 offset:12
    s_mov_b64 exec, -1
    s_setprio 0
    v_mov_b32 v3, 6272
    ds_read_b32 v4, v3 offset:24
    s_waitcnt lgkmcnt(0)
    v_readfirstlane_b32 s4, v4
    s_nop 0
    s_sub_u32 s4, s4, s100
    s_min_i32 s4, s4, 100
    s_max_i32 s4, s4, -200
    s_add_u32 s100, s100, s4
    s_add_u32 s90, s90, s4
    s_add_u32 s91, s91, s4
L_pc_20:
    s_memrealtime s[14:15]
    s_waitcnt lgkmcnt(0)
    s_sub_u32 s15, s90, s14
    s_sub_u32 s15, s15, 1
    s_cmp_ge_u32 s15, 8000
    s_cbranch_scc1 L_pc_21
    s_cmp_ge_u32 s15, 40
    s_cbranch_scc1 L_pc_22
    s_sleep 1
    s_branch L_pc_20
L_pc_22:
    s_sleep 8
    s_branch L_pc_20
L_pc_21:
L_nowd:
    buffer_load_dwordx4 v[64:67], v1, s[44:47], s74 offen offset:0 nt
    buffer_load_dwordx4 v[68:71], v1, s[44:47], s74 offen offset:128 nt
    buffer_load_dwordx4 v[72:75], v1, s[44:47], s74 offen offset:512 nt
    buffer_load_dwordx4 v[76:79], v1, s[44:47], s74 offen offset:640 nt
    buffer_load_dwordx4 v[80:83], v1, s[44:47], s75 offen offset:0 nt
    buffer_load_dwordx4 v[84:87], v1, s[44:47], s75 offen offset:128 nt
    buffer_load_dwordx4 v[88:91], v1, s[44:47], s75 offen offset:512 nt
    buffer_load_dwordx4 v[92:95], v1, s[44:47], s75 offen offset:640 nt
    buffer_load_dwordx4 v[96:99], v1, s[44:47], s76 offen offset:0 nt
    buffer_load_dwordx4 v[100:103], v1, s[44:47], s76 offen offset:128 nt
    buffer_load_dwordx4 v[104:107], v1, s[44:47], s76 offen offset:512 nt
    buffer_load_dwordx4 v[108:111], v1, s[44:47], s76 offen offset:640 nt
    buffer_load_dwordx4 v[112:115], v1, s[44:47], s77 offen offset:0 nt
    buffer_load_dwordx4 v[116:119], v1, s[44:47], s77 offen offset:128 nt
    buffer_load_dwordx4 v[120:123], v1, s[44:47], s77 offen offset:512 nt
    buffer_load_dwordx4 v[124:127], v1, s[44:47], s77 offen offset:640 nt
    v_mov_b32 v3, 6272
    v_mov_b32 v4, 1
    s_mov_b64 exec, 1
    ds_add_u32 v3, v4 offset:16
    s_mov_b64 exec, -1
    v_mov_b32 v3, 6272
    s_mov_b32 s86, 2097152
L_sp_23:
    ds_read_b32 v4, v3 offset:12
    s_waitcnt lgkmcnt(0)
    v_cmp_ne_u32 vcc, 0x4, v4
    s_nop 3
    s_cbranch_vccz L_sp_24
    s_sleep 2
    s_sub_u32 s86, s86, 1
    s_cmp_lg_u32 s86, 0
    s_cbranch_scc1 L_sp_23
L_sp_24:
    v_mov_b32 v3, 6272
    ds_read_b32 v4, v3 offset:24
    s_waitcnt lgkmcnt(0)
    v_readfirstlane_b32 s4, v4
    s_nop 0
    s_sub_u32 s4, s4, s100
    s_min_i32 s4, s4, 100
    s_max_i32 s4, s4, -200
    s_add_u32 s100, s100, s4
    s_add_u32 s90, s90, s4
    s_add_u32 s91, s91, s4
L_kpass:
    v_and_b32 v3, 7, v0
    v_mul_u32_u24 v3, 272, v3
    v_bfe_u32 v4, v0, 3, 1
    v_lshl_add_u32 v3, v4, 6, v3
    v_lshrrev_b32 v4, 4, v0
    v_lshl_add_u32 v3, v4, 4, v3
    ds_read_b128 v[12:15], v3 offset:512
    ds_read_b128 v[16:19], v3 offset:640
    s_waitcnt vmcnt(12) lgkmcnt(0)
    v_mfma_f32_16x16x32_bf16 v[28:31], v[64:67], v[12:15], 0
    v_mfma_f32_16x16x32_bf16 v[32:35], v[72:75], v[12:15], 0
    v_mfma_f32_16x16x32_bf16 v[28:31], v[68:71], v[16:19], v[28:31]
    v_mfma_f32_16x16x32_bf16 v[32:35], v[76:79], v[16:19], v[32:35]
    s_waitcnt vmcnt(8)
    v_mfma_f32_16x16x32_bf16 v[36:39], v[80:83], v[12:15], 0
    v_mfma_f32_16x16x32_bf16 v[40:43], v[88:91], v[12:15], 0
    v_mfma_f32_16x16x32_bf16 v[36:39], v[84:87], v[16:19], v[36:39]
    v_mfma_f32_16x16x32_bf16 v[40:43], v[92:95], v[16:19], v[40:43]
    s_waitcnt vmcnt(4)
    v_mfma_f32_16x16x32_bf16 v[44:47], v[96:99], v[12:15], 0
    v_mfma_f32_16x16x32_bf16 v[48:51], v[104:107], v[12:15], 0
    v_mfma_f32_16x16x32_bf16 v[44:47], v[100:103], v[16:19], v[44:47]
    v_mfma_f32_16x16x32_bf16 v[48:51], v[108:111], v[16:19], v[48:51]
    s_waitcnt vmcnt(0)
    v_mfma_f32_16x16x32_bf16 v[52:55], v[112:115], v[12:15], 0
    v_mfma_f32_16x16x32_bf16 v[56:59], v[120:123], v[12:15], 0
    v_mfma_f32_16x16x32_bf16 v[52:55], v[116:119], v[16:19], v[52:55]
    v_mfma_f32_16x16x32_bf16 v[56:59], v[124:127], v[16:19], v[56:59]
    v_permlane32_swap_b32 v28, v32
    v_permlane32_swap_b32 v29, v33
    v_permlane32_swap_b32 v30, v34
    v_permlane32_swap_b32 v31, v35
    v_permlane32_swap_b32 v36, v40
    v_permlane32_swap_b32 v37, v41
    v_permlane32_swap_b32 v38, v42
    v_permlane32_swap_b32 v39, v43
    v_permlane32_swap_b32 v44, v48
    v_permlane32_swap_b32 v45, v49
    v_permlane32_swap_b32 v46, v50
    v_permlane32_swap_b32 v47, v51
    v_permlane32_swap_b32 v52, v56
    v_permlane32_swap_b32 v53, v57
    v_permlane32_swap_b32 v54, v58
    v_permlane32_swap_b32 v55, v59
    v_add_f32_dpp v28, v32, v28 row_ror:8 row_mask:0xf bank_mask:0xf
    v_add_f32_dpp v29, v33, v29 row_ror:8 row_mask:0xf bank_mask:0xf
    v_add_f32_dpp v30, v34, v30 row_ror:8 row_mask:0xf bank_mask:0xf
    v_add_f32_dpp v31, v35, v31 row_ror:8 row_mask:0xf bank_mask:0xf
    v_add_f32_dpp v36, v40, v36 row_ror:8 row_mask:0xf bank_mask:0xf
    v_add_f32_dpp v37, v41, v37 row_ror:8 row_mask:0xf bank_mask:0xf
    v_add_f32_dpp v38, v42, v38 row_ror:8 row_mask:0xf bank_mask:0xf
    v_add_f32_dpp v39, v43, v39 row_ror:8 row_mask:0xf bank_mask:0xf
    v_add_f32_dpp v44, v48, v44 row_ror:8 row_mask:0xf bank_mask:0xf
    v_add_f32_dpp v45, v49, v45 row_ror:8 row_mask:0xf bank_mask:0xf
    v_add_f32_dpp v46, v50, v46 row_ror:8 row_mask:0xf bank_mask:0xf
    v_add_f32_dpp v47, v51, v47 row_ror:8 row_mask:0xf bank_mask:0xf
    v_add_f32_dpp v52, v56, v52 row_ror:8 row_mask:0xf bank_mask:0xf
    v_add_f32_dpp v53, v57, v53 row_ror:8 row_mask:0xf bank_mask:0xf
    v_add_f32_dpp v54, v58, v54 row_ror:8 row_mask:0xf bank_mask:0xf
    v_add_f32_dpp v55, v59, v55 row_ror:8 row_mask:0xf bank_mask:0xf
    v_cvt_pk_bf16_f32 v20, v28, v29
    v_lshlrev_b32 v28, 16, v20
    v_and_b32 v29, 0xffff0000, v20
    v_mul_f32 v28, s99, v28
    v_mul_f32 v29, s99, v29
    v_cvt_pk_bf16_f32 v20, v28, v29
    v_lshlrev_b32 v28, 16, v20
    v_and_b32 v29, 0xffff0000, v20
    v_cvt_pk_bf16_f32 v21, v30, v31
    v_lshlrev_b32 v30, 16, v21
    v_and_b32 v31, 0xffff0000, v21
    v_mul_f32 v30, s99, v30
    v_mul_f32 v31, s99, v31
    v_cvt_pk_bf16_f32 v21, v30, v31
    v_lshlrev_b32 v30, 16, v21
    v_and_b32 v31, 0xffff0000, v21
    v_cvt_pk_bf16_f32 v22, v36, v37
    v_lshlrev_b32 v36, 16, v22
    v_and_b32 v37, 0xffff0000, v22
    v_mul_f32 v36, s99, v36
    v_mul_f32 v37, s99, v37
    v_cvt_pk_bf16_f32 v22, v36, v37
    v_lshlrev_b32 v36, 16, v22
    v_and_b32 v37, 0xffff0000, v22
    v_cvt_pk_bf16_f32 v23, v38, v39
    v_lshlrev_b32 v38, 16, v23
    v_and_b32 v39, 0xffff0000, v23
    v_mul_f32 v38, s99, v38
    v_mul_f32 v39, s99, v39
    v_cvt_pk_bf16_f32 v23, v38, v39
    v_lshlrev_b32 v38, 16, v23
    v_and_b32 v39, 0xffff0000, v23
    v_cvt_pk_bf16_f32 v24, v44, v45
    v_lshlrev_b32 v44, 16, v24
    v_and_b32 v45, 0xffff0000, v24
    v_mul_f32 v44, s99, v44
    v_mul_f32 v45, s99, v45
    v_cvt_pk_bf16_f32 v24, v44, v45
    v_lshlrev_b32 v44, 16, v24
    v_and_b32 v45, 0xffff0000, v24
    v_cvt_pk_bf16_f32 v25, v46, v47
    v_lshlrev_b32 v46, 16, v25
    v_and_b32 v47, 0xffff0000, v25
    v_mul_f32 v46, s99, v46
    v_mul_f32 v47, s99, v47
    v_cvt_pk_bf16_f32 v25, v46, v47
    v_lshlrev_b32 v46, 16, v25
    v_and_b32 v47, 0xffff0000, v25
    v_cvt_pk_bf16_f32 v26, v52, v53
    v_lshlrev_b32 v52, 16, v26
    v_and_b32 v53, 0xffff0000, v26
    v_mul_f32 v52, s99, v52
    v_mul_f32 v53, s99, v53
    v_cvt_pk_bf16_f32 v26, v52, v53
    v_lshlrev_b32 v52, 16, v26
    v_and_b32 v53, 0xffff0000, v26
    v_cvt_pk_bf16_f32 v27, v54, v55
    v_lshlrev_b32 v54, 16, v27
    v_and_b32 v55, 0xffff0000, v27
    v_mul_f32 v54, s99, v54
    v_mul_f32 v55, s99, v55
    v_cvt_pk_bf16_f32 v27, v54, v55
    v_lshlrev_b32 v54, 16, v27
    v_and_b32 v55, 0xffff0000, v27
    v_max3_f32 v4, v28, v29, v30
    v_max3_f32 v4, v4, v31, v36
    v_max3_f32 v4, v4, v37, v38
    v_max3_f32 v4, v4, v39, v44
    v_max3_f32 v4, v4, v45, v46
    v_max3_f32 v4, v4, v47, v52
    v_max3_f32 v4, v4, v53, v54
    v_max_f32 v4, v4, v55
    v_mov_b32 v5, v4
    s_nop 1
    v_permlane16_swap_b32 v4, v5
    v_max_f32 v4, v4, v5
    v_mov_b32 v5, v4
    s_nop 1
    v_permlane32_swap_b32 v4, v5
    v_max_f32 v4, v4, v5
    v_mul_f32 v6, s87, v4
    v_fma_f32 v28, v28, s87, -v6
    v_fma_f32 v29, v29, s87, -v6
    v_fma_f32 v30, v30, s87, -v6
    v_fma_f32 v31, v31, s87, -v6
    v_fma_f32 v36, v36, s87, -v6
    v_fma_f32 v37, v37, s87, -v6
    v_fma_f32 v38, v38, s87, -v6
    v_fma_f32 v39, v39, s87, -v6
    v_fma_f32 v44, v44, s87, -v6
    v_fma_f32 v45, v45, s87, -v6
    v_fma_f32 v46, v46, s87, -v6
    v_fma_f32 v47, v47, s87, -v6
    v_fma_f32 v52, v52, s87, -v6
    v_fma_f32 v53, v53, s87, -v6
    v_fma_f32 v54, v54, s87, -v6
    v_fma_f32 v55, v55, s87, -v6
    v_exp_f32 v28, v28
    v_exp_f32 v29, v29
    v_exp_f32 v30, v30
    v_exp_f32 v31, v31
    v_exp_f32 v36, v36
    v_exp_f32 v37, v37
    v_exp_f32 v38, v38
    v_exp_f32 v39, v39
    v_exp_f32 v44, v44
    v_exp_f32 v45, v45
    v_exp_f32 v46, v46
    v_exp_f32 v47, v47
    v_exp_f32 v52, v52
    v_exp_f32 v53, v53
    v_exp_f32 v54, v54
    v_exp_f32 v55, v55
    v_add_f32 v5, v28, v29
    v_add_f32 v7, v30, v31
    v_add_f32 v5, v5, v36
    v_add_f32 v7, v7, v37
    v_add_f32 v5, v5, v38
    v_add_f32 v7, v7, v39
    v_add_f32 v5, v5, v44
    v_add_f32 v7, v7, v45
    v_add_f32 v5, v5, v46
    v_add_f32 v7, v7, v47
    v_add_f32 v5, v5, v52
    v_add_f32 v7, v7, v53
    v_add_f32 v5, v5, v54
    v_add_f32 v7, v7, v55
    v_add_f32 v5, v5, v7
    v_mov_b32 v7, v5
    s_nop 1
    v_permlane16_swap_b32 v5, v7
    v_add_f32 v5, v5, v7
    v_mov_b32 v7, v5
    s_nop 1
    v_permlane32_swap_b32 v5, v7
    v_add_f32 v5, v5, v7
    v_cvt_pk_bf16_f32 v20, v28, v29
    v_cvt_pk_bf16_f32 v21, v30, v31
    v_cvt_pk_bf16_f32 v22, v36, v37
    v_cvt_pk_bf16_f32 v23, v38, v39
    v_cvt_pk_bf16_f32 v24, v44, v45
    v_cvt_pk_bf16_f32 v25, v46, v47
    v_cvt_pk_bf16_f32 v26, v52, v53
    v_cvt_pk_bf16_f32 v27, v54, v55
    v_lshlrev_b32 v3, 6, v0
    s_lshl_b32 s4, s3, 2
    v_add_u32 v7, s4, v3
    s_mov_b64 exec, 0xff
    ds_write_b32 v7, v6 offset:4736
    ds_write_b32 v7, v5 offset:5248
    s_mov_b64 exec, -1
    v_mov_b32 v4, 6272
    v_mov_b32 v5, 1
    s_mov_b64 exec, 1
    ds_add_rtn_u32 v5, v4, v5 offset:20
    s_mov_b64 exec, -1
    s_waitcnt lgkmcnt(0)
    v_readfirstlane_b32 s8, v5
    s_nop 0
    s_cmp_lg_u32 s8, 15
    s_nop 1
    s_cbranch_scc1 L_nopub
    s_setprio 3
    v_and_b32 v3, 7, v0
    v_lshlrev_b32 v9, 6, v3
    v_lshrrev_b32 v8, 4, v0
    v_lshl_add_u32 v9, v8, 4, v9
    ds_read_b128 v[44:47], v9 offset:4736
    v_lshrrev_b32 v8, 3, v0
    v_lshlrev_b32 v8, 7, v8
    v_lshl_add_u32 v8, v3, 3, v8
    ds_read_b128 v[48:51], v9 offset:5248
    s_lshl_b32 s6, s78, 7
    s_add_u32 s6, s6, 0x300000
    s_waitcnt lgkmcnt(0)
    v_max3_f32 v6, v44, v45, v46
    v_max_f32 v6, v6, v47
    v_mov_b32 v7, v6
    s_nop 1
    v_permlane16_swap_b32 v6, v7
    v_max_f32 v6, v6, v7
    v_mov_b32 v7, v6
    s_nop 1
    v_permlane32_swap_b32 v6, v7
    v_max_f32 v6, v6, v7
    v_sub_f32 v52, v44, v6
    v_sub_f32 v53, v45, v6
    v_sub_f32 v54, v46, v6
    v_sub_f32 v55, v47, v6
    v_exp_f32 v52, v52
    v_exp_f32 v53, v53
    v_exp_f32 v54, v54
    v_exp_f32 v55, v55
    v_mul_f32 v7, v52, v48
    v_fmac_f32 v7, v53, v49
    v_fmac_f32 v7, v54, v50
    v_fmac_f32 v7, v55, v51
    v_mov_b32 v4, v7
    s_nop 1
    v_permlane16_swap_b32 v7, v4
    v_add_f32 v7, v7, v4
    v_mov_b32 v4, v7
    s_nop 1
    v_permlane32_swap_b32 v7, v4
    v_add_f32 v7, v7, v4
    v_min_u32 v6, -2, v6
    v_min_u32 v7, -2, v7
    s_mov_b64 exec, 0xff
    buffer_store_dwordx2 v[6:7], v8, s[60:63], s6 offen sc1
    s_mov_b64 exec, -1
    s_setprio 0
L_nopub:
    s_cmp_lg_u32 s2, 254
    s_cbranch_scc1 L_notrootb
    s_cmp_lg_u32 s3, 8
    s_cbranch_scc1 L_notrootb
    s_setprio 3
    s_add_u32 s4, s100, 1150
L_pc_25:
    s_memrealtime s[14:15]
    s_waitcnt lgkmcnt(0)
    s_sub_u32 s15, s4, s14
    s_sub_u32 s15, s15, 1
    s_cmp_ge_u32 s15, 8000
    s_cbranch_scc1 L_pc_26
    s_cmp_ge_u32 s15, 40
    s_cbranch_scc1 L_pc_27
    s_sleep 1
    s_branch L_pc_25
L_pc_27:
    s_sleep 8
    s_branch L_pc_25
L_pc_26:
    v_and_b32 v3, 15, v0
    v_lshlrev_b32 v3, 2, v3
    v_bfe_u32 v4, v0, 4, 1
    v_lshl_add_u32 v3, v4, 7, v3
    v_add_u32 v3, 64, v3
    s_mov_b32 s86, 131072
    s_mov_b32 s4, 0x808
L_rbb_p:
    buffer_load_dword v4, v3, s[68:71], 0 offen sc1
    s_waitcnt vmcnt(0)
    v_and_b32 v5, 0xffff, v4
    v_cmp_ne_u32 vcc, s4, v5
    s_nop 0
    s_cmp_eq_u32 vcc_lo, 0
    s_nop 1
    s_cbranch_scc1 L_rbb_d
    s_sleep 8
    s_sub_u32 s86, s86, 1
    s_cmp_lg_u32 s86, 0
    s_cbranch_scc1 L_rbb_p
L_rbb_d:
    v_mov_b32 v56, 2
    v_mov_b32 v57, 2
    v_mov_b32 v58, 2
    v_mov_b32 v59, 2
    v_lshlrev_b32 v3, 7, v0
    s_mov_b32 s4, 0x380040
    buffer_store_dwordx4 v[56:59], v3, s[60:63], s4 offen sc1
    v_mov_b32 v3, 0
    v_lshlrev_b32 v4, 2, v0
    buffer_store_dword v3, v4, s[68:71], 0 offen sc1
    s_waitcnt vmcnt(0)
    s_setprio 0
L_notrootb:
L_vload:
    v_mov_b32 v4, 6272
    s_mov_b32 s86, 2097152
L_sp_28:
    ds_read_b32 v5, v4 offset:16
    s_waitcnt lgkmcnt(0)
    v_cmp_ne_u32 vcc, 0x10, v5
    s_nop 3
    s_cbranch_vccz L_sp_29
    s_sleep 1
    s_sub_u32 s86, s86, 1
    s_cmp_lg_u32 s86, 0
    s_cbranch_scc1 L_sp_28
L_sp_29:
L_pc_30:
    s_memrealtime s[14:15]
    s_waitcnt lgkmcnt(0)
    s_sub_u32 s15, s91, s14
    s_sub_u32 s15, s15, 1
    s_cmp_ge_u32 s15, 8000
    s_cbranch_scc1 L_pc_31
    s_cmp_ge_u32 s15, 40
    s_cbranch_scc1 L_pc_32
    s_sleep 1
    s_branch L_pc_30
L_pc_32:
    s_sleep 8
    s_branch L_pc_30
L_pc_31:
    buffer_load_dwordx4 v[64:67], v2, s[48:51], s74 offen offset:0 nt
    buffer_load_dwordx4 v[68:71], v2, s[48:51], s74 offen offset:1024 nt
    buffer_load_dwordx4 v[72:75], v2, s[48:51], s74 offen offset:2048 nt
    buffer_load_dwordx4 v[76:79], v2, s[48:51], s74 offen offset:3072 nt
    buffer_load_dwordx4 v[80:83], v2, s[48:51], s75 offen offset:0 nt
    buffer_load_dwordx4 v[84:87], v2, s[48:51], s75 offen offset:1024 nt
    buffer_load_dwordx4 v[88:91], v2, s[48:51], s75 offen offset:2048 nt
    buffer_load_dwordx4 v[92:95], v2, s[48:51], s75 offen offset:3072 nt
    buffer_load_dwordx4 v[96:99], v2, s[48:51], s76 offen offset:0 nt
    buffer_load_dwordx4 v[100:103], v2, s[48:51], s76 offen offset:1024 nt
    buffer_load_dwordx4 v[104:107], v2, s[48:51], s76 offen offset:2048 nt
    buffer_load_dwordx4 v[108:111], v2, s[48:51], s76 offen offset:3072 nt
    buffer_load_dwordx4 v[112:115], v2, s[48:51], s77 offen offset:0 nt
    buffer_load_dwordx4 v[116:119], v2, s[48:51], s77 offen offset:1024 nt
    buffer_load_dwordx4 v[120:123], v2, s[48:51], s77 offen offset:2048 nt
    buffer_load_dwordx4 v[124:127], v2, s[48:51], s77 offen offset:3072 nt
    v_and_b32 v3, 15, v0
    v_mul_u32_u24 v4, 528, v3
    v_lshrrev_b32 v5, 4, v0
    v_lshl_add_u32 v4, v5, 7, v4
    s_mul_i32 s4, s3, 4224
    s_add_u32 s4, s4, 6400
    v_add_u32 v4, s4, v4
    v_cmp_gt_u32 vcc, 8, v3
    v_mov_b32 v5, 0
    s_nop 0
    v_cndmask_b32 v4, v5, v4, vcc
    s_lshl_b32 s4, 1, s3
    v_mov_b32 v5, 6272
    v_mov_b32 v6, s4
    s_waitcnt vmcnt(8)
    v_perm_b32 v12, v68, v64, s72
    v_perm_b32 v13, v76, v72, s72
    v_perm_b32 v14, v84, v80, s72
    v_perm_b32 v15, v92, v88, s72
    v_perm_b32 v16, v68, v64, s73
    v_perm_b32 v17, v76, v72, s73
    v_perm_b32 v18, v84, v80, s73
    v_perm_b32 v19, v92, v88, s73
    v_mfma_f32_16x16x32_bf16 v[28:31], v[12:15], v[20:23], 0
    s_nop 0
    v_mfma_f32_16x16x32_bf16 v[32:35], v[16:19], v[20:23], 0
    v_perm_b32 v12, v69, v65, s72
    v_perm_b32 v13, v77, v73, s72
    v_perm_b32 v14, v85, v81, s72
    v_perm_b32 v15, v93, v89, s72
    v_perm_b32 v16, v69, v65, s73
    v_perm_b32 v17, v77, v73, s73
    v_perm_b32 v18, v85, v81, s73
    v_perm_b32 v19, v93, v89, s73
    v_mfma_f32_16x16x32_bf16 v[36:39], v[12:15], v[20:23], 0
    s_nop 0
    v_mfma_f32_16x16x32_bf16 v[40:43], v[16:19], v[20:23], 0
    v_perm_b32 v12, v70, v66, s72
    v_perm_b32 v13, v78, v74, s72
    v_perm_b32 v14, v86, v82, s72
    v_perm_b32 v15, v94, v90, s72
    v_perm_b32 v16, v70, v66, s73
    v_perm_b32 v17, v78, v74, s73
    v_perm_b32 v18, v86, v82, s73
    v_perm_b32 v19, v94, v90, s73
    v_mfma_f32_16x16x32_bf16 v[44:47], v[12:15], v[20:23], 0
    s_nop 0
    v_mfma_f32_16x16x32_bf16 v[48:51], v[16:19], v[20:23], 0
    v_perm_b32 v12, v71, v67, s72
    v_perm_b32 v13, v79, v75, s72
    v_perm_b32 v14, v87, v83, s72
    v_perm_b32 v15, v95, v91, s72
    v_perm_b32 v16, v71, v67, s73
    v_perm_b32 v17, v79, v75, s73
    v_perm_b32 v18, v87, v83, s73
    v_perm_b32 v19, v95, v91, s73
    v_mfma_f32_16x16x32_bf16 v[52:55], v[12:15], v[20:23], 0
    s_nop 0
    v_mfma_f32_16x16x32_bf16 v[56:59], v[16:19], v[20:23], 0
    s_waitcnt vmcnt(0)
    s_setprio 3
    v_perm_b32 v12, v100, v96, s72
    v_perm_b32 v13, v108, v104, s72
    v_perm_b32 v14, v116, v112, s72
    v_perm_b32 v15, v124, v120, s72
    v_perm_b32 v16, v100, v96, s73
    v_perm_b32 v17, v108, v104, s73
    v_perm_b32 v18, v116, v112, s73
    v_perm_b32 v19, v124, v120, s73
    v_mfma_f32_16x16x32_bf16 v[28:31], v[12:15], v[24:27], v[28:31]
    s_nop 0
    v_mfma_f32_16x16x32_bf16 v[32:35], v[16:19], v[24:27], v[32:35]
    v_perm_b32 v12, v101, v97, s72
    v_perm_b32 v13, v109, v105, s72
    v_perm_b32 v14, v117, v113, s72
    v_perm_b32 v15, v125, v121, s72
    v_perm_b32 v16, v101, v97, s73
    v_perm_b32 v17, v109, v105, s73
    v_perm_b32 v18, v117, v113, s73
    v_perm_b32 v19, v125, v121, s73
    v_mfma_f32_16x16x32_bf16 v[36:39], v[12:15], v[24:27], v[36:39]
    s_nop 0
    v_mfma_f32_16x16x32_bf16 v[40:43], v[16:19], v[24:27], v[40:43]
    v_perm_b32 v12, v102, v98, s72
    v_perm_b32 v13, v110, v106, s72
    v_perm_b32 v14, v118, v114, s72
    v_perm_b32 v15, v126, v122, s72
    v_perm_b32 v16, v102, v98, s73
    v_perm_b32 v17, v110, v106, s73
    v_perm_b32 v18, v118, v114, s73
    v_perm_b32 v19, v126, v122, s73
    v_mfma_f32_16x16x32_bf16 v[44:47], v[12:15], v[24:27], v[44:47]
    s_nop 0
    v_mfma_f32_16x16x32_bf16 v[48:51], v[16:19], v[24:27], v[48:51]
    v_perm_b32 v12, v103, v99, s72
    v_perm_b32 v13, v111, v107, s72
    v_perm_b32 v14, v119, v115, s72
    v_perm_b32 v15, v127, v123, s72
    v_perm_b32 v16, v103, v99, s73
    v_perm_b32 v17, v111, v107, s73
    v_perm_b32 v18, v119, v115, s73
    v_perm_b32 v19, v127, v123, s73
    v_mfma_f32_16x16x32_bf16 v[52:55], v[12:15], v[24:27], v[52:55]
    s_nop 0
    v_mfma_f32_16x16x32_bf16 v[56:59], v[16:19], v[24:27], v[56:59]
    ds_write_b128 v4, v[28:31] offset:0
    ds_write_b128 v4, v[32:35] offset:16
    ds_write_b128 v4, v[36:39] offset:32
    ds_write_b128 v4, v[40:43] offset:48
    ds_write_b128 v4, v[44:47] offset:64
    ds_write_b128 v4, v[48:51] offset:80
    ds_write_b128 v4, v[52:55] offset:96
    s_nop 0
    ds_write_b128 v4, v[56:59] offset:112
    s_mov_b64 exec, 1
    ds_add_u32 v5, v6 offset:28
    s_mov_b64 exec, -1
    s_cmp_ge_u32 s3, 12
    s_cbranch_scc1 L_exit
    s_cmp_ge_u32 s3, 8
    s_cbranch_scc1 L_reducer
    s_cmp_eq_u32 s3, 4
    s_cbranch_scc1 L_hjob
    s_cmp_eq_u32 s3, 5
    s_cbranch_scc1 L_stats
    s_cmp_ge_u32 s3, 4
    s_cbranch_scc1 L_tail
    s_cmp_eq_u32 s3, 0
    s_cbranch_scc1 L_exit
    s_cmp_lg_u32 s3, 3
    s_cbranch_scc1 L_gather
    s_branch L_final
L_stats:
    s_setprio 3
    s_add_u32 s4, s100, 2050
L_pc_33:
    s_memrealtime s[14:15]
    s_waitcnt lgkmcnt(0)
    s_sub_u32 s15, s4, s14
    s_sub_u32 s15, s15, 1
    s_cmp_ge_u32 s15, 8000
    s_cbranch_scc1 L_pc_34
    s_cmp_ge_u32 s15, 40
    s_cbranch_scc1 L_pc_35
    s_sleep 1
    s_branch L_pc_33
L_pc_35:
    s_sleep 8
    s_branch L_pc_33
L_pc_34:
    v_mov_b32 v4, 6272
    s_mov_b32 s86, 2097152
L_sp_36:
    ds_read_b32 v5, v4 offset:20
    s_waitcnt lgkmcnt(0)
    v_cmp_ne_u32 vcc, 0x10, v5
    s_nop 3
    s_cbranch_vccz L_sp_37
    s_sleep 1
    s_sub_u32 s86, s86, 1
    s_cmp_lg_u32 s86, 0
    s_cbranch_scc1 L_sp_36
L_sp_37:
    v_and_b32 v3, 7, v0
    v_lshlrev_b32 v9, 6, v3
    v_lshrrev_b32 v8, 4, v0
    v_lshl_add_u32 v9, v8, 4, v9
    ds_read_b128 v[44:47], v9 offset:4736
    v_lshrrev_b32 v8, 3, v0
    v_lshlrev_b32 v8, 7, v8
    v_lshl_add_u32 v8, v3, 3, v8
    s_and_b32 s5, s78, 0xf8
    s_lshl_b32 s5, s5, 7
    s_add_u32 s5, s5, 0x300000
    s_waitcnt lgkmcnt(0)
    s_mov_b32 s86, 131072
L_poll_st:
    buffer_load_dwordx2 v[4:5], v8, s[60:63], s5 offen sc1
    s_waitcnt vmcnt(0)
    v_max_u32 v6, v4, v5
    v_cmp_eq_u32 vcc, -1, v6
    s_nop 3
    s_cbranch_vccz L_poll_st_done
    s_sleep 16
    s_sub_u32 s86, s86, 1
    s_cmp_lg_u32 s86, 0
    s_cbranch_scc1 L_poll_st
L_poll_st_done:
    v_max_f32_dpp v6, v4, v4 row_ror:8 row_mask:0xf bank_mask:0xf
    v_mov_b32 v7, v6
    s_nop 1
    v_permlane16_swap_b32 v6, v7
    v_max_f32 v6, v6, v7
    v_mov_b32 v7, v6
    s_nop 1
    v_permlane32_swap_b32 v6, v7
    v_max_f32 v6, v6, v7
    v_sub_f32 v4, v4, v6
    v_exp_f32 v4, v4
    s_nop 0
    v_mul_f32 v4, v4, v5
    s_nop 1
    v_add_f32_dpp v4, v4, v4 row_ror:8 row_mask:0xf bank_mask:0xf
    v_mov_b32 v7, v4
    s_nop 1
    v_permlane16_swap_b32 v4, v7
    v_add_f32 v4, v4, v7
    v_mov_b32 v7, v4
    s_nop 1
    v_permlane32_swap_b32 v4, v7
    v_add_f32 v4, v4, v7
    v_rcp_f32 v4, v4
    v_sub_f32 v52, v44, v6
    v_sub_f32 v53, v45, v6
    v_sub_f32 v54, v46, v6
    v_sub_f32 v55, v47, v6
    v_exp_f32 v52, v52
    v_exp_f32 v53, v53
    v_exp_f32 v54, v54
    v_exp_f32 v55, v55
    v_mul_f32 v52, v52, v4
    v_mul_f32 v53, v53, v4
    v_mul_f32 v54, v54, v4
    v_mul_f32 v55, v55, v4
    ds_write_b128 v9, v[52:55] offset:5760
    v_mov_b32 v3, 6272
    v_mov_b32 v4, 1
    s_mov_b64 exec, 1
    ds_add_u32 v3, v4 offset:32
    s_mov_b64 exec, -1
    s_branch L_tail
L_hjob:
    s_setprio 3
    s_bfe_u32 s4, s2, 0x50003
    s_mul_i32 s4, s4, 17
    s_add_u32 s4, s4, 1650
    s_add_u32 s4, s4, s100
L_pc_38:
    s_memrealtime s[14:15]
    s_waitcnt lgkmcnt(0)
    s_sub_u32 s15, s4, s14
    s_sub_u32 s15, s15, 1
    s_cmp_ge_u32 s15, 8000
    s_cbranch_scc1 L_pc_39
    s_cmp_ge_u32 s15, 40
    s_cbranch_scc1 L_pc_40
    s_sleep 1
    s_branch L_pc_38
L_pc_40:
    s_sleep 8
    s_branch L_pc_38
L_pc_39:
    s_mov_b32 s86, 131072
    s_mov_b64 exec, 1
L_mbb_p:
    buffer_load_dword v4, off, s[60:63], s101 offset:64 sc1
    s_waitcnt vmcnt(0)
    v_cmp_ne_u32 vcc, 2, v4
    s_nop 3
    s_cbranch_vccz L_mbb_d
    s_sleep 4
    s_sub_u32 s86, s86, 1
    s_cmp_lg_u32 s86, 0
    s_cbranch_scc1 L_mbb_p
L_mbb_d:
    s_mov_b64 exec, -1
    v_mov_b32 v3, 6272
    v_mov_b32 v4, 1
    s_mov_b64 exec, 1
    ds_add_u32 v3, v4 offset:32
    s_mov_b64 exec, -1
    v_cmp_gt_u32 vcc, 48, v0
    v_mov_b32 v6, 0x7ffffff0
    s_nop 0
    v_cndmask_b32 v3, v6, v2, vcc
    s_mul_i32 s4, s83, 1792
    s_add_u32 s4, s4, 0x80000
    s_add_u32 s5, s4, 0x0
    buffer_load_dwordx4 v[64:67], v2, s[60:63], s5 offen offset:0 sc1
    buffer_load_dwordx4 v[68:71], v3, s[60:63], s5 offen offset:1024 sc1
    s_add_u32 s5, s4, 0x1c000
    buffer_load_dwordx4 v[72:75], v2, s[60:63], s5 offen offset:0 sc1
    buffer_load_dwordx4 v[76:79], v3, s[60:63], s5 offen offset:1024 sc1
    s_add_u32 s5, s4, 0x38000
    buffer_load_dwordx4 v[80:83], v2, s[60:63], s5 offen offset:0 sc1
    buffer_load_dwordx4 v[84:87], v3, s[60:63], s5 offen offset:1024 sc1
    s_add_u32 s5, s4, 0x54000
    buffer_load_dwordx4 v[88:91], v2, s[60:63], s5 offen offset:0 sc1
    buffer_load_dwordx4 v[92:95], v3, s[60:63], s5 offen offset:1024 sc1
    s_add_u32 s5, s4, 0x80000
    buffer_load_dwordx4 v[96:99], v2, s[60:63], s5 offen offset:0 sc1
    buffer_load_dwordx4 v[100:103], v3, s[60:63], s5 offen offset:1024 sc1
    s_add_u32 s5, s4, 0x9c000
    buffer_load_dwordx4 v[104:107], v2, s[60:63], s5 offen offset:0 sc1
    buffer_load_dwordx4 v[108:111], v3, s[60:63], s5 offen offset:1024 sc1
    s_add_u32 s5, s4, 0xb8000
    buffer_load_dwordx4 v[112:115], v2, s[60:63], s5 offen offset:0 sc1
    buffer_load_dwordx4 v[116:119], v3, s[60:63], s5 offen offset:1024 sc1
    s_add_u32 s5, s4, 0xd4000
    buffer_load_dwordx4 v[120:123], v2, s[60:63], s5 offen offset:0 sc1
    buffer_load_dwordx4 v[124:127], v3, s[60:63], s5 offen offset:1024 sc1
    v_and_b32 v5, 1, v0
    v_lshlrev_b32 v5, 8, v5
    v_and_b32 v4, 62, v0
    v_add_u32 v5, v5, v4
    s_mov_b32 s4, 0x3d372713
    s_mov_b32 s5, 0xc0135761
    s_waitcnt vmcnt(0)
    v_add_f32 v64, v64, v72
    v_add_f32 v80, v80, v88
    v_add_f32 v28, v64, v80
    v_add_f32 v65, v65, v73
    v_add_f32 v81, v81, v89
    v_add_f32 v29, v65, v81
    v_add_f32 v66, v66, v74
    v_add_f32 v82, v82, v90
    v_add_f32 v30, v66, v82
    v_add_f32 v67, v67, v75
    v_add_f32 v83, v83, v91
    v_add_f32 v31, v67, v83
    v_add_f32 v68, v68, v76
    v_add_f32 v84, v84, v92
    v_add_f32 v32, v68, v84
    v_add_f32 v69, v69, v77
    v_add_f32 v85, v85, v93
    v_add_f32 v33, v69, v85
    v_add_f32 v70, v70, v78
    v_add_f32 v86, v86, v94
    v_add_f32 v34, v70, v86
    v_add_f32 v71, v71, v79
    v_add_f32 v87, v87, v95
    v_add_f32 v35, v71, v87
    v_add_f32 v96, v96, v104
    v_add_f32 v112, v112, v120
    v_add_f32 v36, v96, v112
    v_add_f32 v97, v97, v105
    v_add_f32 v113, v113, v121
    v_add_f32 v37, v97, v113
    v_add_f32 v98, v98, v106
    v_add_f32 v114, v114, v122
    v_add_f32 v38, v98, v114
    v_add_f32 v99, v99, v107
    v_add_f32 v115, v115, v123
    v_add_f32 v39, v99, v115
    v_add_f32 v100, v100, v108
    v_add_f32 v116, v116, v124
    v_add_f32 v40, v100, v116
    v_add_f32 v101, v101, v109
    v_add_f32 v117, v117, v125
    v_add_f32 v41, v101, v117
    v_add_f32 v102, v102, v110
    v_add_f32 v118, v118, v126
    v_add_f32 v42, v102, v118
    v_add_f32 v103, v103, v111
    v_add_f32 v119, v119, v127
    v_add_f32 v43, v103, v119
    v_cvt_pk_bf16_f32 v12, v28, v29
    v_cvt_pk_bf16_f32 v13, v36, v37
    v_lshlrev_b32 v28, 16, v12
    v_and_b32 v29, 0xffff0000, v12
    v_lshlrev_b32 v36, 16, v13
    v_and_b32 v37, 0xffff0000, v13
    v_mul_f32 v14, v28, v28
    v_mul_f32 v14, s4, v14
    v_fma_f32 v14, v14, v28, v28
    v_mul_f32 v14, s5, v14
    v_exp_f32 v14, v14
    s_nop 0
    v_add_f32 v14, 1.0, v14
    v_rcp_f32 v14, v14
    s_nop 0
    v_mul_f32 v14, v14, v28
    v_mul_f32 v15, v29, v29
    v_mul_f32 v15, s4, v15
    v_fma_f32 v15, v15, v29, v29
    v_mul_f32 v15, s5, v15
    v_exp_f32 v15, v15
    s_nop 0
    v_add_f32 v15, 1.0, v15
    v_rcp_f32 v15, v15
    s_nop 0
    v_mul_f32 v15, v15, v29
    v_cvt_pk_bf16_f32 v14, v14, v15
    v_and_b32 v15, 0xffff0000, v14
    v_lshlrev_b32 v14, 16, v14
    v_mul_f32 v14, v14, v36
    v_mul_f32 v15, v15, v37
    v_cvt_pk_bf16_f32 v16, v14, v15
    ds_write_b16 v5, v16 offset:2688
    ds_write_b16_d16_hi v5, v16 offset:2752
    v_cvt_pk_bf16_f32 v12, v30, v31
    v_cvt_pk_bf16_f32 v13, v38, v39
    v_lshlrev_b32 v30, 16, v12
    v_and_b32 v31, 0xffff0000, v12
    v_lshlrev_b32 v38, 16, v13
    v_and_b32 v39, 0xffff0000, v13
    v_mul_f32 v14, v30, v30
    v_mul_f32 v14, s4, v14
    v_fma_f32 v14, v14, v30, v30
    v_mul_f32 v14, s5, v14
    v_exp_f32 v14, v14
    s_nop 0
    v_add_f32 v14, 1.0, v14
    v_rcp_f32 v14, v14
    s_nop 0
    v_mul_f32 v14, v14, v30
    v_mul_f32 v15, v31, v31
    v_mul_f32 v15, s4, v15
    v_fma_f32 v15, v15, v31, v31
    v_mul_f32 v15, s5, v15
    v_exp_f32 v15, v15
    s_nop 0
    v_add_f32 v15, 1.0, v15
    v_rcp_f32 v15, v15
    s_nop 0
    v_mul_f32 v15, v15, v31
    v_cvt_pk_bf16_f32 v14, v14, v15
    v_and_b32 v15, 0xffff0000, v14
    v_lshlrev_b32 v14, 16, v14
    v_mul_f32 v14, v14, v38
    v_mul_f32 v15, v15, v39
    v_cvt_pk_bf16_f32 v17, v14, v15
    ds_write_b16 v5, v17 offset:2816
    ds_write_b16_d16_hi v5, v17 offset:2880
    v_cvt_pk_bf16_f32 v12, v32, v33
    v_cvt_pk_bf16_f32 v13, v40, v41
    v_lshlrev_b32 v32, 16, v12
    v_and_b32 v33, 0xffff0000, v12
    v_lshlrev_b32 v40, 16, v13
    v_and_b32 v41, 0xffff0000, v13
    v_mul_f32 v14, v32, v32
    v_mul_f32 v14, s4, v14
    v_fma_f32 v14, v14, v32, v32
    v_mul_f32 v14, s5, v14
    v_exp_f32 v14, v14
    s_nop 0
    v_add_f32 v14, 1.0, v14
    v_rcp_f32 v14, v14
    s_nop 0
    v_mul_f32 v14, v14, v32
    v_mul_f32 v15, v33, v33
    v_mul_f32 v15, s4, v15
    v_fma_f32 v15, v15, v33, v33
    v_mul_f32 v15, s5, v15
    v_exp_f32 v15, v15
    s_nop 0
    v_add_f32 v15, 1.0, v15
    v_rcp_f32 v15, v15
    s_nop 0
    v_mul_f32 v15, v15, v33
    v_cvt_pk_bf16_f32 v14, v14, v15
    v_and_b32 v15, 0xffff0000, v14
    v_lshlrev_b32 v14, 16, v14
    v_mul_f32 v14, v14, v40
    v_mul_f32 v15, v15, v41
    v_cvt_pk_bf16_f32 v18, v14, v15
    ds_write_b16 v5, v18 offset:3200
    ds_write_b16_d16_hi v5, v18 offset:3264
    v_cvt_pk_bf16_f32 v12, v34, v35
    v_cvt_pk_bf16_f32 v13, v42, v43
    v_lshlrev_b32 v34, 16, v12
    v_and_b32 v35, 0xffff0000, v12
    v_lshlrev_b32 v42, 16, v13
    v_and_b32 v43, 0xffff0000, v13
    v_mul_f32 v14, v34, v34
    v_mul_f32 v14, s4, v14
    v_fma_f32 v14, v14, v34, v34
    v_mul_f32 v14, s5, v14
    v_exp_f32 v14, v14
    s_nop 0
    v_add_f32 v14, 1.0, v14
    v_rcp_f32 v14, v14
    s_nop 0
    v_mul_f32 v14, v14, v34
    v_mul_f32 v15, v35, v35
    v_mul_f32 v15, s4, v15
    v_fma_f32 v15, v15, v35, v35
    v_mul_f32 v15, s5, v15
    v_exp_f32 v15, v15
    s_nop 0
    v_add_f32 v15, 1.0, v15
    v_rcp_f32 v15, v15
    s_nop 0
    v_mul_f32 v15, v15, v35
    v_cvt_pk_bf16_f32 v14, v14, v15
    v_and_b32 v15, 0xffff0000, v14
    v_lshlrev_b32 v14, 16, v14
    v_mul_f32 v14, v14, v42
    v_mul_f32 v15, v15, v43
    v_cvt_pk_bf16_f32 v19, v14, v15
    ds_write_b16 v5, v19 offset:3328
    ds_write_b16_d16_hi v5, v19 offset:3392
    v_mov_b32 v3, 6272
    v_mov_b32 v4, 1
    s_mov_b64 exec, 1
    ds_add_u32 v3, v4 offset:36
    s_mov_b64 exec, -1
    s_branch L_tail
L_gather:
    v_lshrrev_b32 v7, 4, v0
    v_lshlrev_b32 v3, 6, v7
    s_and_b32 s7, s83, 3
    v_xor_b32 v8, s7, v7
    v_lshlrev_b32 v7, 17, v7
    v_lshl_add_u32 v7, v8, 8, v7
    v_and_b32 v8, 15, v0
    v_lshl_add_u32 v7, v8, 4, v7
    s_lshr_b32 s6, s83, 4
    s_lshl_b32 s6, s6, 15
    s_and_b32 s7, s83, 12
    s_lshl_b32 s7, s7, 8
    s_add_u32 s6, s6, s7
    s_sub_u32 s8, s3, 1
    s_lshl_b32 s7, s8, 19
    s_add_u32 s6, s6, s7
    s_add_u32 s6, s6, 0x200000
    v_bfe_u32 v4, v0, 3, 1
    v_lshl_add_u32 v3, v4, 9, v3
    v_and_b32 v4, 7, v0
    v_lshl_add_u32 v3, v4, 3, v3
    s_lshl_b32 s8, s8, 8
    v_add_u32 v3, s8, v3
    s_add_u32 s88, s6, 0
    s_add_u32 s89, s6, 4096
    s_add_u32 s90, s6, 8192
    s_add_u32 s91, s6, 12288
    s_add_u32 s92, s6, 16384
    s_add_u32 s93, s6, 20480
    s_add_u32 s94, s6, 24576
    s_add_u32 s95, s6, 28672
    v_mov_b32 v8, 6272
    s_mov_b32 s86, 2097152
L_sp_41:
    ds_read_b32 v9, v8 offset:4
    s_waitcnt lgkmcnt(0)
    v_cmp_ne_u32 vcc, 0x4, v9
    s_nop 3
    s_cbranch_vccz L_sp_42
    s_sleep 1
    s_sub_u32 s86, s86, 1
    s_cmp_lg_u32 s86, 0
    s_cbranch_scc1 L_sp_41
L_sp_42:
    v_mov_b32 v9, 1
    s_sleep 12
    s_add_u32 s4, s100, 2618
L_pc_43:
    s_memrealtime s[14:15]
    s_waitcnt lgkmcnt(0)
    s_sub_u32 s15, s4, s14
    s_sub_u32 s15, s15, 1
    s_cmp_ge_u32 s15, 8000
    s_cbranch_scc1 L_pc_44
    s_cmp_ge_u32 s15, 40
    s_cbranch_scc1 L_pc_45
    s_sleep 1
    s_branch L_pc_43
L_pc_45:
    s_sleep 8
    s_branch L_pc_43
L_pc_44:
    v_mov_b32 v64, -1
    v_mov_b32 v65, -1
    v_mov_b32 v66, -1
    v_mov_b32 v67, -1
    v_mov_b32 v68, -1
    v_mov_b32 v69, -1
    v_mov_b32 v70, -1
    v_mov_b32 v71, -1
    v_mov_b32 v72, -1
    v_mov_b32 v73, -1
    v_mov_b32 v74, -1
    v_mov_b32 v75, -1
    v_mov_b32 v76, -1
    v_mov_b32 v77, -1
    v_mov_b32 v78, -1
    v_mov_b32 v79, -1
    v_mov_b32 v80, -1
    v_mov_b32 v81, -1
    v_mov_b32 v82, -1
    v_mov_b32 v83, -1
    v_mov_b32 v84, -1
    v_mov_b32 v85, -1
    v_mov_b32 v86, -1
    v_mov_b32 v87, -1
    v_mov_b32 v88, -1
    v_mov_b32 v89, -1
    v_mov_b32 v90, -1
    v_mov_b32 v91, -1
    v_mov_b32 v92, -1
    v_mov_b32 v93, -1
    v_mov_b32 v94, -1
    v_mov_b32 v95, -1
    buffer_load_dwordx4 v[64:67], v7, s[60:63], s88 offen sc1
    buffer_load_dwordx4 v[68:71], v7, s[60:63], s89 offen sc1
    buffer_load_dwordx4 v[72:75], v7, s[60:63], s90 offen sc1
    buffer_load_dwordx4 v[76:79], v7, s[60:63], s91 offen sc1
    buffer_load_dwordx4 v[80:83], v7, s[60:63], s92 offen sc1
    buffer_load_dwordx4 v[84:87], v7, s[60:63], s93 offen sc1
    buffer_load_dwordx4 v[88:91], v7, s[60:63], s94 offen sc1
    buffer_load_dwordx4 v[92:95], v7, s[60:63], s95 offen sc1
    s_mov_b32 s86, 524288
    s_waitcnt vmcnt(0)
L_go_p:
    v_max3_u32 v4, v64, v65, v66
    v_max3_u32 v5, v67, v68, v69
    v_max3_u32 v4, v4, v70, v71
    v_max3_u32 v5, v5, v72, v73
    v_max3_u32 v4, v4, v74, v75
    v_max3_u32 v5, v5, v76, v77
    v_max3_u32 v4, v4, v78, v79
    v_max3_u32 v5, v5, v80, v81
    v_max3_u32 v4, v4, v82, v83
    v_max3_u32 v5, v5, v84, v85
    v_max3_u32 v4, v4, v86, v87
    v_max3_u32 v5, v5, v88, v89
    v_max3_u32 v4, v4, v90, v91
    v_max3_u32 v5, v5, v92, v93
    v_max3_u32 v4, v4, v94, v95
    v_max_u32 v4, v4, v5
    v_cmp_eq_u32 vcc, -1, v4
    s_nop 3
    s_cbranch_vccz L_go_d
    v_max3_u32 v4, v64, v65, v66
    v_max_u32 v4, v4, v67
    v_cmp_eq_u32 vcc, -1, v4
    s_nop 3
    s_cbranch_vccz L_fs_46
    s_mov_b64 exec, vcc
    buffer_load_dwordx4 v[64:67], v7, s[60:63], s88 offen sc1
    s_mov_b64 exec, -1
L_fs_46:
    v_max3_u32 v4, v68, v69, v70
    v_max_u32 v4, v4, v71
    v_cmp_eq_u32 vcc, -1, v4
    s_nop 3
    s_cbranch_vccz L_fs_47
    s_mov_b64 exec, vcc
    buffer_load_dwordx4 v[68:71], v7, s[60:63], s89 offen sc1
    s_mov_b64 exec, -1
L_fs_47:
    v_max3_u32 v4, v72, v73, v74
    v_max_u32 v4, v4, v75
    v_cmp_eq_u32 vcc, -1, v4
    s_nop 3
    s_cbranch_vccz L_fs_48
    s_mov_b64 exec, vcc
    buffer_load_dwordx4 v[72:75], v7, s[60:63], s90 offen sc1
    s_mov_b64 exec, -1
L_fs_48:
    v_max3_u32 v4, v76, v77, v78
    v_max_u32 v4, v4, v79
    v_cmp_eq_u32 vcc, -1, v4
    s_nop 3
    s_cbranch_vccz L_fs_49
    s_mov_b64 exec, vcc
    buffer_load_dwordx4 v[76:79], v7, s[60:63], s91 offen sc1
    s_mov_b64 exec, -1
L_fs_49:
    v_max3_u32 v4, v80, v81, v82
    v_max_u32 v4, v4, v83
    v_cmp_eq_u32 vcc, -1, v4
    s_nop 3
    s_cbranch_vccz L_fs_50
    s_mov_b64 exec, vcc
    buffer_load_dwordx4 v[80:83], v7, s[60:63], s92 offen sc1
    s_mov_b64 exec, -1
L_fs_50:
    v_max3_u32 v4, v84, v85, v86
    v_max_u32 v4, v4, v87
    v_cmp_eq_u32 vcc, -1, v4
    s_nop 3
    s_cbranch_vccz L_fs_51
    s_mov_b64 exec, vcc
    buffer_load_dwordx4 v[84:87], v7, s[60:63], s93 offen sc1
    s_mov_b64 exec, -1
L_fs_51:
    v_max3_u32 v4, v88, v89, v90
    v_max_u32 v4, v4, v91
    v_cmp_eq_u32 vcc, -1, v4
    s_nop 3
    s_cbranch_vccz L_fs_52
    s_mov_b64 exec, vcc
    buffer_load_dwordx4 v[88:91], v7, s[60:63], s94 offen sc1
    s_mov_b64 exec, -1
L_fs_52:
    v_max3_u32 v4, v92, v93, v94
    v_max_u32 v4, v4, v95
    v_cmp_eq_u32 vcc, -1, v4
    s_nop 3
    s_cbranch_vccz L_fs_53
    s_mov_b64 exec, vcc
    buffer_load_dwordx4 v[92:95], v7, s[60:63], s95 offen sc1
    s_mov_b64 exec, -1
L_fs_53:
    s_sleep 6
    s_waitcnt vmcnt(24)
    s_sub_u32 s86, s86, 1
    s_cmp_lg_u32 s86, 0
    s_cbranch_scc1 L_go_p
L_go_d:
    v_add_f32 v28, v64, v68
    v_add_f32 v29, v65, v69
    v_add_f32 v30, v66, v70
    v_add_f32 v31, v67, v71
    v_add_f32 v32, v72, v76
    v_add_f32 v33, v73, v77
    v_add_f32 v34, v74, v78
    v_add_f32 v35, v75, v79
    v_add_f32 v36, v80, v84
    v_add_f32 v37, v81, v85
    v_add_f32 v38, v82, v86
    v_add_f32 v39, v83, v87
    v_add_f32 v40, v88, v92
    v_add_f32 v41, v89, v93
    v_add_f32 v42, v90, v94
    v_add_f32 v43, v91, v95
    v_add_f32 v28, v28, v32
    v_add_f32 v29, v29, v33
    v_add_f32 v30, v30, v34
    v_add_f32 v31, v31, v35
    v_add_f32 v36, v36, v40
    v_add_f32 v37, v37, v41
    v_add_f32 v38, v38, v42
    v_add_f32 v39, v39, v43
    v_add_f32 v12, v28, v36
    v_add_f32 v13, v29, v37
    v_add_f32 v14, v30, v38
    v_add_f32 v15, v31, v39
    v_cvt_pk_bf16_f32 v12, v12, v13
    v_cvt_pk_bf16_f32 v13, v14, v15
    ds_write_b64 v3, v[12:13] offset:3712
    s_mov_b64 exec, 1
    ds_add_u32 v8, v9 offset:40
    s_mov_b64 exec, -1
    s_branch L_exit
L_reducer:
    v_lshrrev_b32 v3, 5, v0
    s_sub_u32 s6, s3, 8
    s_lshl_b32 s4, s6, 1
    v_add_u32 v3, s4, v3
    v_lshlrev_b32 v6, 6, v3
    v_mul_u32_u24 v3, 528, v3
    v_and_b32 v4, 31, v0
    v_lshl_add_u32 v3, v4, 4, v3
    v_add_u32 v3, 6400, v3
    s_lshl_b32 s4, s78, 12
    s_lshl_b32 s5, s6, 10
    s_add_u32 s4, s4, s5
    s_add_u32 s4, s4, 0x200000
    s_and_b32 s5, s79, 3
    s_lshl_b32 s5, s5, 8
    v_xor_b32 v7, s5, v2
    v_mov_b32 v8, 6272
    s_mov_b32 s86, 2097152
L_sp_54:
    ds_read_b32 v9, v8 offset:32
    s_waitcnt lgkmcnt(0)
    v_cmp_ne_u32 vcc, 0x2, v9
    s_nop 3
    s_cbranch_vccz L_sp_55
    s_sleep 1
    s_sub_u32 s86, s86, 1
    s_cmp_lg_u32 s86, 0
    s_cbranch_scc1 L_sp_54
L_sp_55:
    ds_read_b128 v[12:15], v6 offset:5760
    ds_read_b128 v[16:19], v6 offset:5776
    ds_read_b128 v[20:23], v6 offset:5792
    ds_read_b128 v[24:27], v6 offset:5808
    v_mov_b32 v8, 6272
    s_mov_b32 s86, 2097152
L_sp_56:
    ds_read_b32 v9, v8 offset:28
    s_waitcnt lgkmcnt(0)
    v_and_b32 v9, 0xfff0, v9
    v_cmp_ne_u32 vcc, 0xfff0, v9
    s_nop 3
    s_cbranch_vccz L_sp_57
    s_sleep 1
    s_sub_u32 s86, s86, 1
    s_cmp_lg_u32 s86, 0
    s_cbranch_scc1 L_sp_56
L_sp_57:
    ds_read_b128 v[80:83], v3 offset:16896
    ds_read_b128 v[84:87], v3 offset:21120
    ds_read_b128 v[88:91], v3 offset:25344
    ds_read_b128 v[92:95], v3 offset:29568
    ds_read_b128 v[96:99], v3 offset:33792
    ds_read_b128 v[100:103], v3 offset:38016
    ds_read_b128 v[104:107], v3 offset:42240
    ds_read_b128 v[108:111], v3 offset:46464
    ds_read_b128 v[112:115], v3 offset:50688
    ds_read_b128 v[116:119], v3 offset:54912
    ds_read_b128 v[120:123], v3 offset:59136
    ds_read_b128 v[124:127], v3 offset:63360
    s_waitcnt lgkmcnt(0)
    v_mul_f32 v28, v16, v80
    v_mul_f32 v29, v16, v81
    v_mul_f32 v30, v16, v82
    v_mul_f32 v31, v16, v83
    v_fmac_f32 v28, v17, v84
    v_fmac_f32 v29, v17, v85
    v_fmac_f32 v30, v17, v86
    v_fmac_f32 v31, v17, v87
    v_fmac_f32 v28, v18, v88
    v_fmac_f32 v29, v18, v89
    v_fmac_f32 v30, v18, v90
    v_fmac_f32 v31, v18, v91
    v_fmac_f32 v28, v19, v92
    v_fmac_f32 v29, v19, v93
    v_fmac_f32 v30, v19, v94
    v_fmac_f32 v31, v19, v95
    v_fmac_f32 v28, v20, v96
    v_fmac_f32 v29, v20, v97
    v_fmac_f32 v30, v20, v98
    v_fmac_f32 v31, v20, v99
    v_fmac_f32 v28, v21, v100
    v_fmac_f32 v29, v21, v101
    v_fmac_f32 v30, v21, v102
    v_fmac_f32 v31, v21, v103
    v_fmac_f32 v28, v22, v104
    v_fmac_f32 v29, v22, v105
    v_fmac_f32 v30, v22, v106
    v_fmac_f32 v31, v22, v107
    v_fmac_f32 v28, v23, v108
    v_fmac_f32 v29, v23, v109
    v_fmac_f32 v30, v23, v110
    v_fmac_f32 v31, v23, v111
    v_fmac_f32 v28, v24, v112
    v_fmac_f32 v29, v24, v113
    v_fmac_f32 v30, v24, v114
    v_fmac_f32 v31, v24, v115
    v_fmac_f32 v28, v25, v116
    v_fmac_f32 v29, v25, v117
    v_fmac_f32 v30, v25, v118
    v_fmac_f32 v31, v25, v119
    v_fmac_f32 v28, v26, v120
    v_fmac_f32 v29, v26, v121
    v_fmac_f32 v30, v26, v122
    v_fmac_f32 v31, v26, v123
    v_fmac_f32 v28, v27, v124
    v_fmac_f32 v29, v27, v125
    v_fmac_f32 v30, v27, v126
    v_fmac_f32 v31, v27, v127
    v_mov_b32 v8, 6272
    s_mov_b32 s86, 2097152
L_sp_58:
    ds_read_b32 v9, v8 offset:28
    s_waitcnt lgkmcnt(0)
    v_cmp_ne_u32 vcc, 0xffff, v9
    s_nop 3
    s_cbranch_vccz L_sp_59
    s_sub_u32 s86, s86, 1
    s_cmp_lg_u32 s86, 0
    s_cbranch_scc1 L_sp_58
L_sp_59:
    ds_read_b128 v[64:67], v3 offset:0
    ds_read_b128 v[68:71], v3 offset:4224
    ds_read_b128 v[72:75], v3 offset:8448
    ds_read_b128 v[76:79], v3 offset:12672
    s_waitcnt lgkmcnt(3)
    v_fmac_f32 v28, v12, v64
    v_fmac_f32 v29, v12, v65
    v_fmac_f32 v30, v12, v66
    v_fmac_f32 v31, v12, v67
    s_waitcnt lgkmcnt(2)
    v_fmac_f32 v28, v13, v68
    v_fmac_f32 v29, v13, v69
    v_fmac_f32 v30, v13, v70
    v_fmac_f32 v31, v13, v71
    s_waitcnt lgkmcnt(1)
    v_fmac_f32 v28, v14, v72
    v_fmac_f32 v29, v14, v73
    v_fmac_f32 v30, v14, v74
    v_fmac_f32 v31, v14, v75
    s_waitcnt lgkmcnt(0)
    v_fmac_f32 v28, v15, v76
    v_fmac_f32 v29, v15, v77
    v_fmac_f32 v30, v15, v78
    v_fmac_f32 v31, v15, v79
    v_min_u32 v28, -2, v28
    v_min_u32 v29, -2, v29
    v_min_u32 v30, -2, v30
    v_min_u32 v31, -2, v31
    buffer_store_dwordx4 v[28:31], v7, s[60:63], s4 offen sc1
    v_mov_b32 v8, 6272
    v_mov_b32 v9, 1
    s_mov_b64 exec, 1
    ds_add_u32 v8, v9 offset:4
    s_mov_b64 exec, -1
    s_branch L_exit
L_tail:
    s_setprio 2
    v_lshrrev_b32 v3, 4, v0
    v_bfe_u32 v4, v0, 2, 2
    v_lshl_add_u32 v5, v3, 3, v4
    v_lshlrev_b32 v5, 7, v5
    v_and_b32 v6, 3, v0
    v_lshl_add_u32 v5, v6, 3, v5
    v_and_b32 v4, 2, v4
    v_and_b32 v6, 1, v3
    v_lshl_add_u32 v4, v6, 2, v4
    v_lshl_add_u32 v5, v4, 4, v5
    s_sub_u32 s4, s3, 4
    s_lshl_b32 s5, s4, 14
    s_add_u32 s5, s5, 75776
    v_add_u32 v5, s5, v5
    v_cmp_le_u32 vcc, 48, v0
    v_mov_b32 v6, 2048
    s_nop 0
    v_cndmask_b32 v6, 0, v6, vcc
    v_xor_b32 v44, 0, v5
    v_sub_u32 v48, v44, v6
    v_xor_b32 v45, 32, v5
    v_sub_u32 v49, v45, v6
    v_xor_b32 v46, 64, v5
    v_sub_u32 v50, v46, v6
    v_xor_b32 v47, 96, v5
    v_sub_u32 v51, v47, v6
    v_and_b32 v6, 7, v0
    v_lshlrev_b32 v6, 6, v6
    v_lshl_add_u32 v6, v3, 4, v6
    s_lshl_b32 s12, s2, 13
    s_lshl_b32 s13, s4, 11
    s_add_u32 s12, s12, s13
    s_add_u32 s12, s12, 0x400000
    s_and_b32 s13, s83, 7
    s_lshl_b32 s13, s13, 7
    v_xor_b32 v52, s13, v2
    v_xor_b32 v53, 0x200, v52
    s_cmp_lt_u32 s2, 224
    s_movk_i32 s8, 2481
    s_cselect_b32 s8, 2481, s8
    s_add_u32 s9, s4, 1
    s_and_b32 s9, s9, 3
    s_mul_i32 s9, s9, 31
    s_add_u32 s8, s8, s9
    s_add_u32 s8, s8, s100
L_pc_60:
    s_memrealtime s[14:15]
    s_waitcnt lgkmcnt(0)
    s_sub_u32 s15, s8, s14
    s_sub_u32 s15, s15, 1
    s_cmp_ge_u32 s15, 8000
    s_cbranch_scc1 L_pc_61
    s_cmp_ge_u32 s15, 40
    s_cbranch_scc1 L_pc_62
    s_sleep 1
    s_branch L_pc_60
L_pc_62:
    s_sleep 8
    s_branch L_pc_60
L_pc_61:
    s_mov_b32 s56, s24
    s_and_b32 s57, s25, 0xffff
    s_mov_b32 s58, 0x800000
    s_mov_b32 s59, 0x00020000
    v_lshrrev_b32 v4, 3, v0
    v_and_b32 v3, 3, v4
    v_lshlrev_b32 v3, 14, v3
    v_lshrrev_b32 v5, 5, v0
    v_lshl_add_u32 v3, v5, 11, v3
    v_and_b32 v4, 2, v4
    v_and_b32 v5, 7, v0
    v_xor_b32 v5, v4, v5
    v_lshl_add_u32 v3, v5, 4, v3
    v_xor_b32 v4, 64, v3
    s_mul_i32 s8, s83, 131072
    s_lshl_b32 s9, s82, 9
    s_add_u32 s8, s8, s9
    s_sub_u32 s9, s3, 4
    s_lshl_b32 s10, s9, 11
    s_add_u32 s10, s10, 83968
    s_lshr_b32 s11, s9, 1
    s_lshl_b32 s11, s11, 16
    s_add_u32 s8, s8, s11
    s_and_b32 s11, s9, 1
    s_lshl_b32 s11, s11, 13
    s_add_u32 s8, s8, s11
    s_add_u32 s11, s8, 0
    s_add_u32 m0, s10, 0
    s_nop 0
    buffer_load_dwordx4 v3, s[56:59], s11 offen nt lds
    s_add_u32 s11, s8, 128
    s_add_u32 m0, s10, 16384
    s_nop 0
    buffer_load_dwordx4 v3, s[56:59], s11 offen nt lds
    s_add_u32 s11, s8, 256
    s_add_u32 m0, s10, 32768
    s_nop 0
    buffer_load_dwordx4 v3, s[56:59], s11 offen nt lds
    s_add_u32 s11, s8, 384
    s_add_u32 m0, s10, 49152
    s_nop 0
    buffer_load_dwordx4 v3, s[56:59], s11 offen nt lds
    s_add_u32 s11, s8, 4096
    s_add_u32 m0, s10, 1024
    s_nop 0
    buffer_load_dwordx4 v4, s[56:59], s11 offen nt lds
    s_add_u32 s11, s8, 4224
    s_add_u32 m0, s10, 17408
    s_nop 0
    buffer_load_dwordx4 v4, s[56:59], s11 offen nt lds
    s_add_u32 s11, s8, 4352
    s_add_u32 m0, s10, 33792
    s_nop 0
    buffer_load_dwordx4 v4, s[56:59], s11 offen nt lds
    s_add_u32 s11, s8, 4480
    s_add_u32 m0, s10, 50176
    s_nop 0
    buffer_load_dwordx4 v4, s[56:59], s11 offen nt lds
L_twe_63:
    v_mov_b32 v8, 6272
    s_mov_b32 s86, 2097152
L_sp_64:
    ds_read_b32 v9, v8 offset:20
    s_waitcnt lgkmcnt(0)
    v_cmp_ne_u32 vcc, 0x10, v9
    s_nop 3
    s_cbranch_vccz L_sp_65
    s_sleep 1
    s_sub_u32 s86, s86, 1
    s_cmp_lg_u32 s86, 0
    s_cbranch_scc1 L_sp_64
L_sp_65:
    ds_read_b64_tr_b16 v[64:65], v44 offset:0
    ds_read_b64_tr_b16 v[66:67], v44 offset:512
    ds_read_b64_tr_b16 v[68:69], v45 offset:0
    ds_read_b64_tr_b16 v[70:71], v45 offset:512
    ds_read_b64_tr_b16 v[72:73], v46 offset:0
    ds_read_b64_tr_b16 v[74:75], v46 offset:512
    ds_read_b64_tr_b16 v[76:77], v47 offset:0
    ds_read_b64_tr_b16 v[78:79], v47 offset:512
    ds_read_b64_tr_b16 v[80:81], v48 offset:4096
    ds_read_b64_tr_b16 v[82:83], v48 offset:4608
    ds_read_b64_tr_b16 v[84:85], v49 offset:4096
    ds_read_b64_tr_b16 v[86:87], v49 offset:4608
    ds_read_b64_tr_b16 v[88:89], v50 offset:4096
    ds_read_b64_tr_b16 v[90:91], v50 offset:4608
    ds_read_b64_tr_b16 v[92:93], v51 offset:4096
    ds_read_b64_tr_b16 v[94:95], v51 offset:4608
    v_mov_b32 v8, 6272
    s_mov_b32 s86, 2097152
L_sp_66:
    ds_read_b32 v9, v8 offset:36
    s_waitcnt lgkmcnt(0)
    v_cmp_ne_u32 vcc, 0x1, v9
    s_nop 3
    s_cbranch_vccz L_sp_67
    s_sleep 1
    s_sub_u32 s86, s86, 1
    s_cmp_lg_u32 s86, 0
    s_cbranch_scc1 L_sp_66
L_sp_67:
    ds_read_b128 v[12:15], v6 offset:2688
    ds_read_b128 v[16:19], v6 offset:3200
    s_waitcnt lgkmcnt(0)
    v_mfma_f32_16x16x32_bf16 v[28:31], v[12:15], v[64:67], 0
    v_mfma_f32_16x16x32_bf16 v[32:35], v[12:15], v[68:71], 0
    v_mfma_f32_16x16x32_bf16 v[36:39], v[12:15], v[72:75], 0
    v_mfma_f32_16x16x32_bf16 v[40:43], v[12:15], v[76:79], 0
    v_mfma_f32_16x16x32_bf16 v[28:31], v[16:19], v[80:83], v[28:31]
    v_mfma_f32_16x16x32_bf16 v[32:35], v[16:19], v[84:87], v[32:35]
    v_mfma_f32_16x16x32_bf16 v[36:39], v[16:19], v[88:91], v[36:39]
    v_mfma_f32_16x16x32_bf16 v[40:43], v[16:19], v[92:95], v[40:43]
    s_waitcnt vmcnt(0)
    s_setprio 3
    v_mov_b32 v8, 6272
    v_mov_b32 v9, 1
    s_mov_b64 exec, 1
    ds_add_u32 v8, v9 offset:68
    s_mov_b64 exec, -1
    v_mov_b32 v8, 6272
    s_mov_b32 s86, 2097152
L_sp_68:
    ds_read_b32 v9, v8 offset:68
    s_waitcnt lgkmcnt(0)
    v_cmp_ne_u32 vcc, 0x4, v9
    s_nop 3
    s_cbranch_vccz L_sp_69
    s_sub_u32 s86, s86, 1
    s_cmp_lg_u32 s86, 0
    s_cbranch_scc1 L_sp_68
L_sp_69:
    ds_read_b64_tr_b16 v[96:97], v44 offset:8192
    ds_read_b64_tr_b16 v[98:99], v44 offset:8704
    ds_read_b64_tr_b16 v[100:101], v45 offset:8192
    ds_read_b64_tr_b16 v[102:103], v45 offset:8704
    ds_read_b64_tr_b16 v[104:105], v46 offset:8192
    ds_read_b64_tr_b16 v[106:107], v46 offset:8704
    ds_read_b64_tr_b16 v[108:109], v47 offset:8192
    ds_read_b64_tr_b16 v[110:111], v47 offset:8704
    ds_read_b64_tr_b16 v[112:113], v44 offset:12288
    ds_read_b64_tr_b16 v[114:115], v44 offset:12800
    ds_read_b64_tr_b16 v[116:117], v45 offset:12288
    ds_read_b64_tr_b16 v[118:119], v45 offset:12800
    ds_read_b64_tr_b16 v[120:121], v46 offset:12288
    ds_read_b64_tr_b16 v[122:123], v46 offset:12800
    ds_read_b64_tr_b16 v[124:125], v47 offset:12288
    ds_read_b64_tr_b16 v[126:127], v47 offset:12800
    v_mov_b32 v8, 6272
    s_mov_b32 s86, 2097152
L_sp_70:
    ds_read_b32 v9, v8 offset:40
    s_waitcnt lgkmcnt(0)
    v_cmp_ne_u32 vcc, 0x2, v9
    s_nop 3
    s_cbranch_vccz L_sp_71
    s_sub_u32 s86, s86, 1
    s_cmp_lg_u32 s86, 0
    s_cbranch_scc1 L_sp_70
L_sp_71:
    ds_read_b128 v[12:15], v6 offset:3712
    ds_read_b128 v[16:19], v6 offset:4224
    s_waitcnt lgkmcnt(0)
    v_mfma_f32_16x16x32_bf16 v[28:31], v[12:15], v[96:99], v[28:31]
    v_mfma_f32_16x16x32_bf16 v[32:35], v[12:15], v[100:103], v[32:35]
    v_mfma_f32_16x16x32_bf16 v[36:39], v[12:15], v[104:107], v[36:39]
    v_mfma_f32_16x16x32_bf16 v[40:43], v[12:15], v[108:111], v[40:43]
    v_mfma_f32_16x16x32_bf16 v[28:31], v[16:19], v[112:115], v[28:31]
    v_mfma_f32_16x16x32_bf16 v[32:35], v[16:19], v[116:119], v[32:35]
    v_mfma_f32_16x16x32_bf16 v[36:39], v[16:19], v[120:123], v[36:39]
    v_mfma_f32_16x16x32_bf16 v[40:43], v[16:19], v[124:127], v[40:43]
    s_mov_b32 exec_hi, 0
    s_nop 3
    v_min_u32 v28, -2, v28
    v_min_u32 v29, -2, v29
    v_min_u32 v30, -2, v30
    v_min_u32 v31, -2, v31
    buffer_store_dwordx4 v[28:31], v52, s[60:63], s12 offen offset:0 sc1
    v_min_u32 v32, -2, v32
    v_min_u32 v33, -2, v33
    v_min_u32 v34, -2, v34
    v_min_u32 v35, -2, v35
    buffer_store_dwordx4 v[32:35], v53, s[60:63], s12 offen offset:0 sc1
    v_min_u32 v36, -2, v36
    v_min_u32 v37, -2, v37
    v_min_u32 v38, -2, v38
    v_min_u32 v39, -2, v39
    buffer_store_dwordx4 v[36:39], v52, s[60:63], s12 offen offset:1024 sc1
    v_min_u32 v40, -2, v40
    v_min_u32 v41, -2, v41
    v_min_u32 v42, -2, v42
    v_min_u32 v43, -2, v43
    buffer_store_dwordx4 v[40:43], v53, s[60:63], s12 offen offset:1024 sc1
    s_mov_b64 exec, -1
    v_mov_b32 v8, 6272
    v_mov_b32 v9, 1
    s_mov_b64 exec, 1
    ds_add_u32 v8, v9 offset:60
    s_mov_b64 exec, -1
    s_branch L_exit
L_final:
    s_lshr_b32 s4, s83, 2
    s_lshl_b32 s4, s4, 4
    s_lshl_b32 s5, s82, 8
    s_add_u32 s4, s4, s5
    s_and_b32 s5, s83, 1
    s_lshl_b32 s5, s5, 3
    s_add_u32 s4, s4, s5
    s_bfe_u32 s5, s83, 0x10001
    s_lshl_b32 s5, s5, 12
    s_add_u32 s4, s4, s5
    s_lshl_b32 s4, s4, 1
    v_lshrrev_b32 v3, 3, v0
    v_and_b32 v4, 7, v0
    v_lshlrev_b32 v5, 11, v3
    v_lshl_add_u32 v5, v4, 1, v5
    v_add_u32 v5, s4, v5
    v_cmp_gt_u32 vcc, 32, v0
    v_mov_b32 v6, 0x7ffffff0
    s_nop 0
    v_cndmask_b32 v5, v6, v5, vcc
    buffer_load_ushort v9, v5, s[40:43], 0 offen
    v_lshlrev_b32 v6, 13, v3
    v_lshl_add_u32 v6, v4, 4, v6
    s_and_b32 s5, s83, 7
    v_xor_b32 v4, s5, v3
    v_lshl_add_u32 v6, v4, 7, v6
    s_lshl_b32 s5, s82, 19
    s_and_b32 s6, s83, 56
    s_lshl_b32 s6, s6, 7
    s_add_u32 s5, s5, s6
    s_add_u32 s5, s5, 0x400000
    s_add_u32 s88, s5, 0
    s_add_u32 s89, s5, 65536
    s_add_u32 s90, s5, 131072
    s_add_u32 s91, s5, 196608
    s_add_u32 s92, s5, 262144
    s_add_u32 s93, s5, 327680
    s_add_u32 s94, s5, 393216
    s_add_u32 s95, s5, 458752
    v_mov_b32 v7, 6272
    s_mov_b32 s86, 2097152
L_sp_72:
    ds_read_b32 v8, v7 offset:60
    s_waitcnt lgkmcnt(0)
    v_cmp_ne_u32 vcc, 0x4, v8
    s_nop 3
    s_cbranch_vccz L_sp_73
    s_sleep 1
    s_sub_u32 s86, s86, 1
    s_cmp_lg_u32 s86, 0
    s_cbranch_scc1 L_sp_72
L_sp_73:
    s_sleep 18
    v_mov_b32 v64, -1
    v_mov_b32 v65, -1
    v_mov_b32 v66, -1
    v_mov_b32 v67, -1
    v_mov_b32 v68, -1
    v_mov_b32 v69, -1
    v_mov_b32 v70, -1
    v_mov_b32 v71, -1
    v_mov_b32 v72, -1
    v_mov_b32 v73, -1
    v_mov_b32 v74, -1
    v_mov_b32 v75, -1
    v_mov_b32 v76, -1
    v_mov_b32 v77, -1
    v_mov_b32 v78, -1
    v_mov_b32 v79, -1
    v_mov_b32 v80, -1
    v_mov_b32 v81, -1
    v_mov_b32 v82, -1
    v_mov_b32 v83, -1
    v_mov_b32 v84, -1
    v_mov_b32 v85, -1
    v_mov_b32 v86, -1
    v_mov_b32 v87, -1
    v_mov_b32 v88, -1
    v_mov_b32 v89, -1
    v_mov_b32 v90, -1
    v_mov_b32 v91, -1
    v_mov_b32 v92, -1
    v_mov_b32 v93, -1
    v_mov_b32 v94, -1
    v_mov_b32 v95, -1
    buffer_load_dwordx4 v[64:67], v6, s[60:63], s88 offen sc1
    buffer_load_dwordx4 v[68:71], v6, s[60:63], s89 offen sc1
    buffer_load_dwordx4 v[72:75], v6, s[60:63], s90 offen sc1
    buffer_load_dwordx4 v[76:79], v6, s[60:63], s91 offen sc1
    buffer_load_dwordx4 v[80:83], v6, s[60:63], s92 offen sc1
    buffer_load_dwordx4 v[84:87], v6, s[60:63], s93 offen sc1
    buffer_load_dwordx4 v[88:91], v6, s[60:63], s94 offen sc1
    buffer_load_dwordx4 v[92:95], v6, s[60:63], s95 offen sc1
    s_mov_b32 s86, 524288
    s_waitcnt vmcnt(0)
L_fo_p:
    v_max3_u32 v7, v64, v65, v66
    v_max3_u32 v8, v67, v68, v69
    v_max3_u32 v7, v7, v70, v71
    v_max3_u32 v8, v8, v72, v73
    v_max3_u32 v7, v7, v74, v75
    v_max3_u32 v8, v8, v76, v77
    v_max3_u32 v7, v7, v78, v79
    v_max3_u32 v8, v8, v80, v81
    v_max3_u32 v7, v7, v82, v83
    v_max3_u32 v8, v8, v84, v85
    v_max3_u32 v7, v7, v86, v87
    v_max3_u32 v8, v8, v88, v89
    v_max3_u32 v7, v7, v90, v91
    v_max3_u32 v8, v8, v92, v93
    v_max3_u32 v7, v7, v94, v95
    v_max_u32 v7, v7, v8
    v_cmp_eq_u32 vcc, -1, v7
    s_nop 3
    s_cbranch_vccz L_fo_d
    v_max3_u32 v7, v64, v65, v66
    v_max_u32 v7, v7, v67
    v_cmp_eq_u32 vcc, -1, v7
    s_nop 3
    s_cbranch_vccz L_fs_74
    s_mov_b64 exec, vcc
    buffer_load_dwordx4 v[64:67], v6, s[60:63], s88 offen sc1
    s_mov_b64 exec, -1
L_fs_74:
    v_max3_u32 v7, v68, v69, v70
    v_max_u32 v7, v7, v71
    v_cmp_eq_u32 vcc, -1, v7
    s_nop 3
    s_cbranch_vccz L_fs_75
    s_mov_b64 exec, vcc
    buffer_load_dwordx4 v[68:71], v6, s[60:63], s89 offen sc1
    s_mov_b64 exec, -1
L_fs_75:
    v_max3_u32 v7, v72, v73, v74
    v_max_u32 v7, v7, v75
    v_cmp_eq_u32 vcc, -1, v7
    s_nop 3
    s_cbranch_vccz L_fs_76
    s_mov_b64 exec, vcc
    buffer_load_dwordx4 v[72:75], v6, s[60:63], s90 offen sc1
    s_mov_b64 exec, -1
L_fs_76:
    v_max3_u32 v7, v76, v77, v78
    v_max_u32 v7, v7, v79
    v_cmp_eq_u32 vcc, -1, v7
    s_nop 3
    s_cbranch_vccz L_fs_77
    s_mov_b64 exec, vcc
    buffer_load_dwordx4 v[76:79], v6, s[60:63], s91 offen sc1
    s_mov_b64 exec, -1
L_fs_77:
    v_max3_u32 v7, v80, v81, v82
    v_max_u32 v7, v7, v83
    v_cmp_eq_u32 vcc, -1, v7
    s_nop 3
    s_cbranch_vccz L_fs_78
    s_mov_b64 exec, vcc
    buffer_load_dwordx4 v[80:83], v6, s[60:63], s92 offen sc1
    s_mov_b64 exec, -1
L_fs_78:
    v_max3_u32 v7, v84, v85, v86
    v_max_u32 v7, v7, v87
    v_cmp_eq_u32 vcc, -1, v7
    s_nop 3
    s_cbranch_vccz L_fs_79
    s_mov_b64 exec, vcc
    buffer_load_dwordx4 v[84:87], v6, s[60:63], s93 offen sc1
    s_mov_b64 exec, -1
L_fs_79:
    v_max3_u32 v7, v88, v89, v90
    v_max_u32 v7, v7, v91
    v_cmp_eq_u32 vcc, -1, v7
    s_nop 3
    s_cbranch_vccz L_fs_80
    s_mov_b64 exec, vcc
    buffer_load_dwordx4 v[88:91], v6, s[60:63], s94 offen sc1
    s_mov_b64 exec, -1
L_fs_80:
    v_max3_u32 v7, v92, v93, v94
    v_max_u32 v7, v7, v95
    v_cmp_eq_u32 vcc, -1, v7
    s_nop 3
    s_cbranch_vccz L_fs_81
    s_mov_b64 exec, vcc
    buffer_load_dwordx4 v[92:95], v6, s[60:63], s95 offen sc1
    s_mov_b64 exec, -1
L_fs_81:
    s_sleep 6
    s_waitcnt vmcnt(24)
    s_sub_u32 s86, s86, 1
    s_cmp_lg_u32 s86, 0
    s_cbranch_scc1 L_fo_p
L_fo_d:
    v_add_f32 v28, v64, v68
    v_add_f32 v29, v65, v69
    v_add_f32 v30, v66, v70
    v_add_f32 v31, v67, v71
    v_add_f32 v32, v72, v76
    v_add_f32 v33, v73, v77
    v_add_f32 v34, v74, v78
    v_add_f32 v35, v75, v79
    v_add_f32 v36, v80, v84
    v_add_f32 v37, v81, v85
    v_add_f32 v38, v82, v86
    v_add_f32 v39, v83, v87
    v_add_f32 v40, v88, v92
    v_add_f32 v41, v89, v93
    v_add_f32 v42, v90, v94
    v_add_f32 v43, v91, v95
    v_add_f32 v28, v28, v32
    v_add_f32 v29, v29, v33
    v_add_f32 v30, v30, v34
    v_add_f32 v31, v31, v35
    v_add_f32 v36, v36, v40
    v_add_f32 v37, v37, v41
    v_add_f32 v38, v38, v42
    v_add_f32 v39, v39, v43
    v_add_f32 v12, v28, v36
    v_add_f32 v13, v29, v37
    v_add_f32 v14, v30, v38
    v_add_f32 v15, v31, v39
    v_add_f32_dpp v12, v12, v12 row_ror:8 row_mask:0xf bank_mask:0xf
    v_add_f32_dpp v13, v13, v13 row_ror:8 row_mask:0xf bank_mask:0xf
    v_add_f32_dpp v14, v14, v14 row_ror:8 row_mask:0xf bank_mask:0xf
    v_add_f32_dpp v15, v15, v15 row_ror:8 row_mask:0xf bank_mask:0xf
    v_mov_b32 v16, v12
    s_nop 1
    v_permlane16_swap_b32 v12, v16
    v_add_f32 v12, v12, v16
    v_mov_b32 v16, v12
    s_nop 1
    v_permlane32_swap_b32 v12, v16
    v_add_f32 v12, v12, v16
    v_mov_b32 v17, v13
    s_nop 1
    v_permlane16_swap_b32 v13, v17
    v_add_f32 v13, v13, v17
    v_mov_b32 v17, v13
    s_nop 1
    v_permlane32_swap_b32 v13, v17
    v_add_f32 v13, v13, v17
    v_mov_b32 v18, v14
    s_nop 1
    v_permlane16_swap_b32 v14, v18
    v_add_f32 v14, v14, v18
    v_mov_b32 v18, v14
    s_nop 1
    v_permlane32_swap_b32 v14, v18
    v_add_f32 v14, v14, v18
    v_mov_b32 v19, v15
    s_nop 1
    v_permlane16_swap_b32 v15, v19
    v_add_f32 v15, v15, v19
    v_mov_b32 v19, v15
    s_nop 1
    v_permlane32_swap_b32 v15, v19
    v_add_f32 v15, v15, v19
    v_cmp_eq_u32 vcc, 1, v3
    s_nop 1
    v_cndmask_b32 v7, v12, v13, vcc
    v_cmp_eq_u32 vcc, 2, v3
    s_nop 1
    v_cndmask_b32 v7, v7, v14, vcc
    v_cmp_eq_u32 vcc, 3, v3
    s_nop 1
    v_cndmask_b32 v7, v7, v15, vcc
    v_lshlrev_b32 v9, 16, v9
    v_add_f32 v7, v7, v9
    v_cvt_pk_bf16_f32 v7, v7, v7
    buffer_store_short v7, v5, s[64:67], 0 offen sc1
L_exit:
L_end:
    s_endpgm
.section .rodata,"a"
.p2align 6
.amdhsa_kernel parallel_sum__gqa_block_cached__glu_gated_geglu__decode_kernel
  .amdhsa_next_free_vgpr 128
  .amdhsa_next_free_sgpr 102
  .amdhsa_accum_offset 128
  .amdhsa_group_segment_fixed_size 0
  .amdhsa_kernarg_size 96
  .amdhsa_user_sgpr_count 2
  .amdhsa_user_sgpr_kernarg_segment_ptr 1
  .amdhsa_system_sgpr_workgroup_id_x 1
.end_amdhsa_kernel
```
